```python
import torch

def _softmax(x, axis=-1):
    return torch.softmax(x, dim=axis)
def _gelu(x):
    return torch.nn.functional.gelu(x, approximate="tanh")
def _silu(x):
    return torch.nn.functional.silu(x)
def _sigmoid(x):
    return torch.sigmoid(x)
def _layernorm(x, axis=-1, eps=1e-5):
    m = x.mean(dim=axis, keepdim=True)
    v = x.var(dim=axis, keepdim=True, unbiased=False)
    return (x - m) / torch.sqrt(v + eps)
def _scatter_add(tgt, idx, src, axis=0):
    return tgt.clone().index_add_(axis, idx, src)
def _segment_sum(src, seg, n):
    out = torch.zeros((n,) + src.shape[1:], dtype=src.dtype)
    return out.index_add_(0, seg, src)
def _pad(x, pw):
    flat = tuple(v for pair in reversed(pw) for v in pair)
    return torch.nn.functional.pad(x, flat)

kernel_name = 'parallel_sum__sliding_block_cached__mixer_channel_mlp__decode'

def setup_inputs():

    _w = (lambda a: (lambda t: t.to(torch.bfloat16) if t.is_floating_point() else t)(torch.as_tensor(a)))
    def _A_setup():
        B, Sq, D = 2, 1, 1024
        Hq, Hkv, Sk, Dh = 32, 4, 16384, 128
        assert Hq % Hkv == 0, (Hq, Hkv)
        return {
            "x": _w((lambda *s: torch.randn(*s, dtype=torch.bfloat16) * 0.05)(B, Sq, D)),
            "k_cache": _w((lambda *s: torch.randn(*s, dtype=torch.bfloat16) * 3.2)(B, Hkv, Sk, Dh)),
            "v_cache": _w((lambda *s: torch.randn(*s, dtype=torch.bfloat16) * 0.4)(B, Hkv, Sk, Dh)),
            "wq": _w((lambda *s: torch.randn(*s, dtype=torch.bfloat16) * 3.2)(D, Hq * Dh) * (D ** -0.5)),
            "wo": _w((lambda *s: torch.randn(*s, dtype=torch.bfloat16) * 0.4)(Hq * Dh, D) * ((Hq * Dh) ** -0.5)),
        }
    _A_in = _A_setup()

    def _B_setup():
        B, S, D, F = 2, 1, 1024, 3584
        return {
            "x": _w((lambda *s: torch.randn(*s, dtype=torch.bfloat16) * 0.05)(B, S, D)),
            "w1": _w((lambda *s: torch.randn(*s, dtype=torch.bfloat16) * 1.6)(D, F) * (D ** -0.5)),
            "b1": _w((lambda *s: torch.randn(*s, dtype=torch.bfloat16) * 0.8)(F)),
            "w2": _w((lambda *s: torch.randn(*s, dtype=torch.bfloat16) * 0.1)(F, D) * (F ** -0.5)),
            "b2": _w((lambda *s: torch.randn(*s, dtype=torch.bfloat16) * 0.1)(D)),
        }
    _B_in = _B_setup()

    return {
        "A_x": _A_in["x"],
        "A_k_cache": _A_in["k_cache"],
        "A_v_cache": _A_in["v_cache"],
        "A_wq": _A_in["wq"],
        "A_wo": _A_in["wo"],
        "B_x": _B_in["x"],
        "B_w1": _B_in["w1"],
        "B_b1": _B_in["b1"],
        "B_w2": _B_in["w2"],
        "B_b2": _B_in["b2"],
    }

def reference(A_x, A_k_cache, A_v_cache, A_wq, A_wo, B_x, B_w1, B_b1, B_w2, B_b2):
    def _A_ref(x, k_cache, v_cache, wq, wo):
        B, Sq, D = x.shape
        Hq, Dh = 32, 128
        Hkv, Sk = k_cache.shape[1], k_cache.shape[2]
        W = min(4096, max(256, Sk // 4))
        rep = Hq // Hkv
        q = (lambda x, *d: x.permute(*d))((x @ wq).reshape(B, Sq, Hq, Dh), 0, 2, 1, 3)
        k = (lambda x, n, axis: torch.repeat_interleave(x, n, dim=axis))(k_cache[:, :, Sk - W:, :], rep, axis=1)
        v = (lambda x, n, axis: torch.repeat_interleave(x, n, dim=axis))(v_cache[:, :, Sk - W:, :], rep, axis=1)
        scores = torch.einsum("bhqd,bhkd->bhqk", q, k) * (Dh ** -0.5)
        p = _softmax(scores, axis=-1)
        o = torch.einsum("bhqk,bhkd->bhqd", p, v)
        return (lambda x, *d: x.permute(*d))(o, 0, 2, 1, 3).reshape(B, Sq, Hq * Dh) @ wo

    def _B_ref(x, w1, b1, w2, b2):
        y = _layernorm(x, axis=-1)
        h = _gelu(torch.einsum("bsd,df->bsf", y, w1) + b1)
        return torch.einsum("bsf,fd->bsd", h, w2) + b2

    x = A_x
    xn = _layernorm(x, axis=-1)
    return x + _A_ref(xn, A_k_cache, A_v_cache, A_wq, A_wo) + _B_ref(xn, B_w1, B_b1, B_w2, B_b2)
```

```asm
; @launch grid=(256,1,1) block=(576,1,1) lds=87936
.amdgcn_target "amdgcn-amd-amdhsa--gfx950"
.text
.globl parallel_sum__sliding_block_cached__mixer_channel_mlp__decode_kernel
.p2align 12
.fill 832, 4, 0xbf800000
.p2align 8
.type parallel_sum__sliding_block_cached__mixer_channel_mlp__decode_kernel,@function
parallel_sum__sliding_block_cached__mixer_channel_mlp__decode_kernel:
s_cmp_ge_u32 s2, 256
s_cbranch_scc1 L_end
s_load_dwordx16 s[72:87], s[0:1], 0
s_load_dwordx2 s[56:57], s[0:1], 96
v_lshrrev_b32 v4, 6, v0
v_and_b32 v1, 63, v0
v_readfirstlane_b32 s3, v4
v_mov_b32 v2, 0
v_mov_b32 v3, 1
s_and_b32 s4, s2, 7
s_lshr_b32 s5, s2, 3
s_lshr_b32 s14, s5, 2
s_lshl_b32 s15, s14, 3
s_add_u32 s6, s4, 3
s_and_b32 s6, s6, 7
s_add_u32 s6, s6, s15
s_add_u32 s8, s4, 2
s_and_b32 s8, s8, 7
s_add_u32 s8, s8, s15
s_and_b32 s7, s5, 3
s_cmp_lt_u32 s14, 7
s_cselect_b32 s9, 1, 0
s_mov_b32 s10, 0
s_mov_b32 s58, 268435456
s_mov_b32 s59, 0x20000
s_cmp_lt_u32 s3, 4
s_cbranch_scc1 L_S
s_setprio 3
s_sub_u32 s3, s3, 4
s_mov_b32 s26, 4096
s_mov_b32 s27, 0x20000
v_lshlrev_b32 v4, 4, v1
v_lshlrev_b32 v16, 3, v1
s_and_b32 s16, s3, 1
s_lshl_b32 s14, s16, 11
s_lshl_b32 s15, s7, 9
s_add_u32 s15, s15, s14
v_lshlrev_b32 v17, 2, v1
s_mov_b32 exec_hi, 0
ds_write_b32 v17, v2 offset:16128
s_mov_b64 exec, -1
s_cmp_eq_u32 s3, 4
s_waitcnt lgkmcnt(0)
s_mov_b64 s[24:25], s[72:73]
s_barrier
s_cbranch_scc1 L_C
buffer_load_dwordx4 v[20:23], v4, s[24:27], s14 offen
buffer_load_dwordx4 v[24:27], v4, s[24:27], s14 offen offset:1024
buffer_load_dwordx2 v[28:29], v16, s[24:27], s15 offen
s_branch L_C
L_S:
s_load_dwordx2 s[52:53], s[0:1], 64
s_mov_b32 s34, 8388608
s_mov_b32 s35, 0x20000
s_mov_b32 s38, 33554432
s_mov_b32 s39, 0x20000
s_mov_b32 s42, 33554432
s_mov_b32 s43, 0x20000
s_cmp_lg_u32 s9, 0
s_cselect_b32 s46, 7340032, 0
s_cselect_b32 s54, 7340032, 0
s_mov_b32 s47, 0x20000
s_mov_b32 s50, 8388608
s_mov_b32 s51, 0x20000
s_mov_b32 s55, 0x20000
s_lshl_b32 s14, s7, 8
s_lshl_b32 s15, s3, 6
s_add_u32 s14, s14, s15
s_lshl_b32 s60, s14, 13
s_lshl_b32 s15, s6, 7
s_add_u32 s60, s60, s15
s_mul_i32 s63, s14, 7168
s_lshl_b32 s15, s8, 7
s_add_u32 s63, s63, s15
s_lshl_b32 s14, s7, 9
s_lshl_b32 s15, s3, 15
s_add_u32 s14, s14, s15
s_lshl_b32 s64, s6, 17
s_add_u32 s64, s64, s14
s_lshl_b32 s65, s8, 17
s_add_u32 s65, s65, s14
s_lshl_b32 s61, s4, 22
s_lshl_b32 s15, s3, 18
s_add_u32 s61, s61, s15
s_add_u32 s61, s61, 3145728
s_mov_b32 s62, s61
s_mul_i32 s66, s3, 8704
s_add_u32 s66, s66, 16256
s_mul_i32 s67, s3, 9216
s_add_u32 s67, s67, 51072
v_lshrrev_b32 v20, 4, v1
v_bfe_u32 v21, v1, 3, 1
v_and_b32 v22, 7, v1
v_lshl_add_u32 v23, v20, 2, v21
v_lshlrev_b32 v24, 4, v22
v_lshl_add_u32 v18, v23, 13, v24
v_mul_u32_u24 v25, 7168, v23
v_add_u32 v19, v25, v24
v_and_b32 v25, 15, v1
v_lshlrev_b32 v4, 4, v25
v_lshl_add_u32 v4, v20, 11, v4
v_xor_b32 v26, v25, v20
v_lshlrev_b32 v26, 4, v26
v_lshl_add_u32 v5, v20, 8, v26
v_lshlrev_b32 v26, 1, v20
v_xor_b32 v26, v25, v26
v_lshlrev_b32 v26, 4, v26
v_lshl_add_u32 v6, v20, 8, v26
s_waitcnt lgkmcnt(0)
s_mov_b64 s[32:33], s[78:79]
buffer_load_dwordx4 v[64:67], v18, s[32:35], s60 offen nt
s_barrier
s_add_u32 s60, s60, 16384
buffer_load_dwordx4 v[68:71], v18, s[32:35], s60 offen nt
s_add_u32 s60, s60, 114688
buffer_load_dwordx4 v[72:75], v18, s[32:35], s60 offen nt
s_add_u32 s60, s60, 16384
buffer_load_dwordx4 v[76:79], v18, s[32:35], s60 offen nt
s_add_u32 s60, s60, 114688
buffer_load_dwordx4 v[80:83], v18, s[32:35], s60 offen nt
s_load_dword s11, s[56:57], 0
s_lshl_b32 s88, s5, 10
s_mov_b32 s92, 0x8000
s_add_u32 s89, s88, 0x2000
s_and_b32 s89, s89, 0x7c00
s_add_u32 s90, s89, 0x2000
s_and_b32 s90, s90, 0x7c00
s_add_u32 s91, s90, 0x2000
s_and_b32 s91, s91, 0x7c00
s_mov_b64 s[36:37], s[74:75]
s_mov_b64 s[40:41], s[76:77]
s_mov_b64 s[44:45], s[84:85]
s_mov_b64 s[48:49], s[80:81]
v_and_b32 v25, 1, v1
v_bfe_u32 v26, v1, 1, 2
v_mov_b32 v27, 0xffff
v_lshlrev_b32 v25, 4, v25
v_lshlrev_b32 v27, v25, v27
v_cmp_eq_u32 vcc, 0, v26
s_nop 1
v_cndmask_b32 v8, 0, v27, vcc
v_cmp_eq_u32 vcc, 1, v26
s_nop 1
v_cndmask_b32 v9, 0, v27, vcc
v_cmp_eq_u32 vcc, 2, v26
s_nop 1
v_cndmask_b32 v10, 0, v27, vcc
v_cmp_eq_u32 vcc, 3, v26
s_nop 1
v_cndmask_b32 v11, 0, v27, vcc
v_lshlrev_b32 v25, 4, v20
v_lshl_add_u32 v12, v21, 8, v25
v_lshl_add_u32 v7, v21, 10, v25
s_lshl_b32 s14, s3, 8
v_add_u32 v7, s14, v7
v_lshrrev_b32 v25, 1, v20
v_and_b32 v26, 1, v20
v_lshlrev_b32 v27, 5, v22
v_lshl_add_u32 v27, v26, 4, v27
v_lshl_add_u32 v13, v25, 8, v27
s_lshl_b32 s14, s3, 9
v_add_u32 v13, s14, v13
s_mov_b32 s18, 0xff00ff00
s_mov_b32 s19, 0xff00ff00
s_lshl_b32 s14, s3, 6
v_add_u32 v12, s14, v12
v_lshlrev_b32 v15, 4, v1
s_lshl_b32 s14, s3, 11
v_add_u32 v16, s14, v15
s_and_b32 s14, s3, 1
s_lshl_b32 s14, s14, 10
s_lshr_b32 s15, s3, 1
s_lshl_b32 s15, s15, 9
s_add_u32 s14, s14, s15
v_add_u32 v15, s14, v15
v_and_b32 v27, 15, v1
v_lshlrev_b32 v27, 5, v27
v_lshl_add_u32 v14, v26, 4, v27
s_lshl_b32 s14, s7, 10
s_and_b32 s15, s3, 1
s_lshl_b32 s15, s15, 9
s_add_u32 s14, s14, s15
s_lshr_b32 s15, s3, 1
s_lshl_b32 s15, s15, 12
s_add_u32 s14, s14, s15
s_mul_i32 s15, s6, 8192
s_add_u32 s14, s14, s15
s_add_u32 s68, s14, 409600
s_waitcnt vmcnt(4)
s_add_u32 s60, s60, 16384
buffer_load_dwordx4 v[84:87], v18, s[32:35], s60 offen nt
s_waitcnt vmcnt(4)
s_add_u32 s60, s60, 114688
buffer_load_dwordx4 v[88:91], v18, s[32:35], s60 offen nt
s_waitcnt vmcnt(4)
s_add_u32 s60, s60, 16384
buffer_load_dwordx4 v[92:95], v18, s[32:35], s60 offen nt
s_waitcnt vmcnt(4)
s_add_u32 s16, s88, s61
s_add_u32 m0, s66, 0
s_nop 0
buffer_load_dwordx4 v5, s[36:39], s16 offen nt lds
s_waitcnt vmcnt(4)
s_add_u32 s61, s61, s92
s_add_u32 s16, s89, s61
s_add_u32 m0, s66, 1088
s_nop 0
buffer_load_dwordx4 v5, s[36:39], s16 offen nt lds
PL_1:
ds_read_b32 v60, v2 offset:16128
ds_read_b128 v[20:23], v7 offset:0
ds_read_b128 v[24:27], v7 offset:64
ds_read_b128 v[28:31], v7 offset:128
ds_read_b128 v[32:35], v7 offset:192
s_waitcnt lgkmcnt(0)
v_readfirstlane_b32 s14, v60
s_cmp_ge_u32 s14, 2
s_cbranch_scc1 PD_2
s_add_u32 s10, s10, 1
s_cmp_lt_u32 s10, 1048576
s_cbranch_scc1 PL_1
s_mov_b32 s15, 1
s_branch L_fail
PD_2:
v_and_b32 v36, v20, v8
v_and_b32 v37, v20, v9
v_and_b32 v38, v20, v10
v_and_b32 v39, v20, v11
v_and_b32 v40, v21, v8
v_and_b32 v41, v21, v9
v_and_b32 v42, v21, v10
v_and_b32 v43, v21, v11
v_mfma_f32_16x16x32_bf16 v[52:55], v[36:39], v[64:67], 0
v_and_b32 v36, v22, v8
v_and_b32 v37, v22, v9
v_and_b32 v38, v22, v10
v_and_b32 v39, v22, v11
v_mfma_f32_16x16x32_bf16 v[56:59], v[40:43], v[64:67], 0
v_and_b32 v40, v23, v8
v_and_b32 v41, v23, v9
v_and_b32 v42, v23, v10
v_and_b32 v43, v23, v11
v_mfma_f32_16x16x32_bf16 v[52:55], v[36:39], v[68:71], v[52:55]
v_and_b32 v36, v24, v8
v_and_b32 v37, v24, v9
v_and_b32 v38, v24, v10
v_and_b32 v39, v24, v11
v_mfma_f32_16x16x32_bf16 v[56:59], v[40:43], v[68:71], v[56:59]
v_and_b32 v40, v25, v8
v_and_b32 v41, v25, v9
v_and_b32 v42, v25, v10
v_and_b32 v43, v25, v11
v_mfma_f32_16x16x32_bf16 v[52:55], v[36:39], v[72:75], v[52:55]
v_and_b32 v36, v26, v8
v_and_b32 v37, v26, v9
v_and_b32 v38, v26, v10
v_and_b32 v39, v26, v11
v_mfma_f32_16x16x32_bf16 v[56:59], v[40:43], v[72:75], v[56:59]
v_and_b32 v40, v27, v8
v_and_b32 v41, v27, v9
v_and_b32 v42, v27, v10
v_and_b32 v43, v27, v11
v_mfma_f32_16x16x32_bf16 v[52:55], v[36:39], v[76:79], v[52:55]
v_and_b32 v36, v28, v8
v_and_b32 v37, v28, v9
v_and_b32 v38, v28, v10
v_and_b32 v39, v28, v11
v_mfma_f32_16x16x32_bf16 v[56:59], v[40:43], v[76:79], v[56:59]
v_and_b32 v40, v29, v8
v_and_b32 v41, v29, v9
v_and_b32 v42, v29, v10
v_and_b32 v43, v29, v11
v_mfma_f32_16x16x32_bf16 v[52:55], v[36:39], v[80:83], v[52:55]
v_and_b32 v36, v30, v8
v_and_b32 v37, v30, v9
v_and_b32 v38, v30, v10
v_and_b32 v39, v30, v11
v_mfma_f32_16x16x32_bf16 v[56:59], v[40:43], v[80:83], v[56:59]
v_and_b32 v40, v31, v8
v_and_b32 v41, v31, v9
v_and_b32 v42, v31, v10
v_and_b32 v43, v31, v11
s_waitcnt vmcnt(4)
s_add_u32 s61, s61, s92
s_add_u32 s16, s90, s61
s_add_u32 m0, s66, 2176
s_nop 0
buffer_load_dwordx4 v5, s[36:39], s16 offen nt lds
v_mfma_f32_16x16x32_bf16 v[52:55], v[36:39], v[84:87], v[52:55]
v_and_b32 v36, v32, v8
v_and_b32 v37, v32, v9
v_and_b32 v38, v32, v10
v_and_b32 v39, v32, v11
v_mfma_f32_16x16x32_bf16 v[56:59], v[40:43], v[84:87], v[56:59]
v_and_b32 v40, v33, v8
v_and_b32 v41, v33, v9
v_and_b32 v42, v33, v10
v_and_b32 v43, v33, v11
s_waitcnt vmcnt(4)
s_add_u32 s61, s61, s92
s_add_u32 s16, s91, s61
s_add_u32 m0, s66, 3264
s_nop 0
buffer_load_dwordx4 v5, s[36:39], s16 offen nt lds
v_mfma_f32_16x16x32_bf16 v[52:55], v[36:39], v[88:91], v[52:55]
v_and_b32 v36, v34, v8
v_and_b32 v37, v34, v9
v_and_b32 v38, v34, v10
v_and_b32 v39, v34, v11
v_mfma_f32_16x16x32_bf16 v[56:59], v[40:43], v[88:91], v[56:59]
v_and_b32 v40, v35, v8
v_and_b32 v41, v35, v9
v_and_b32 v42, v35, v10
v_and_b32 v43, v35, v11
s_waitcnt vmcnt(4)
s_add_u32 s61, s61, s92
s_add_u32 s16, s88, s61
s_add_u32 m0, s66, 4352
s_nop 0
buffer_load_dwordx4 v5, s[36:39], s16 offen nt lds
v_mfma_f32_16x16x32_bf16 v[52:55], v[36:39], v[92:95], v[52:55]
v_mfma_f32_16x16x32_bf16 v[56:59], v[40:43], v[92:95], v[56:59]
s_nop 7
v_cndmask_b32 v60, v52, v56, s[18:19]
v_cndmask_b32 v61, v53, v57, s[18:19]
v_cndmask_b32 v62, v54, v58, s[18:19]
v_cndmask_b32 v63, v55, v59, s[18:19]
v_add_f32_dpp v60, v60, v60 row_ror:8 row_mask:0xf bank_mask:0xf
v_add_f32_dpp v61, v61, v61 row_ror:8 row_mask:0xf bank_mask:0xf
v_add_f32_dpp v62, v62, v62 row_ror:8 row_mask:0xf bank_mask:0xf
v_add_f32_dpp v63, v63, v63 row_ror:8 row_mask:0xf bank_mask:0xf
s_mov_b32 exec_lo, 0x00ff00ff
s_mov_b32 exec_hi, 0x00ff00ff
ds_write_b128 v13, v[60:63] offset:4096
s_mov_b64 exec, 1
ds_add_u32 v2, v3 offset:16136
s_mov_b64 exec, -1
s_waitcnt vmcnt(4)
s_add_u32 s61, s61, s92
s_add_u32 s16, s89, s61
s_add_u32 m0, s66, 5440
s_nop 0
buffer_load_dwordx4 v5, s[36:39], s16 offen nt lds
s_waitcnt vmcnt(4)
s_add_u32 s61, s61, s92
s_add_u32 s16, s90, s61
s_add_u32 m0, s66, 6528
s_nop 0
buffer_load_dwordx4 v5, s[36:39], s16 offen nt lds
s_waitcnt vmcnt(4)
s_add_u32 s61, s61, s92
s_add_u32 s16, s91, s61
s_add_u32 m0, s66, 7616
s_nop 0
buffer_load_dwordx4 v5, s[36:39], s16 offen nt lds
s_waitcnt vmcnt(4)
s_add_u32 s16, s88, s62
s_add_u32 m0, s67, 0
s_nop 0
buffer_load_dwordx4 v6, s[40:43], s16 offen nt lds
s_waitcnt vmcnt(4)
s_add_u32 s62, s62, s92
s_add_u32 s16, s89, s62
s_add_u32 m0, s67, 1152
s_nop 0
buffer_load_dwordx4 v6, s[40:43], s16 offen nt lds
s_waitcnt vmcnt(4)
s_add_u32 s62, s62, s92
s_add_u32 s16, s90, s62
s_add_u32 m0, s67, 2304
s_nop 0
buffer_load_dwordx4 v6, s[40:43], s16 offen nt lds
s_waitcnt vmcnt(4)
s_add_u32 s62, s62, s92
s_add_u32 s16, s91, s62
s_add_u32 m0, s67, 3456
s_nop 0
buffer_load_dwordx4 v6, s[40:43], s16 offen nt lds
s_waitcnt vmcnt(4)
s_add_u32 s62, s62, s92
s_add_u32 s16, s88, s62
s_add_u32 m0, s67, 4608
s_nop 0
buffer_load_dwordx4 v6, s[40:43], s16 offen nt lds
s_mov_b64 exec, 1
ds_add_u32 v2, v3 offset:16140
s_mov_b64 exec, -1
s_waitcnt vmcnt(4)
s_add_u32 s62, s62, s92
s_add_u32 s16, s89, s62
s_add_u32 m0, s67, 5760
s_nop 0
buffer_load_dwordx4 v6, s[40:43], s16 offen nt lds
s_waitcnt vmcnt(4)
s_add_u32 s62, s62, s92
s_add_u32 s16, s90, s62
s_add_u32 m0, s67, 6912
s_nop 0
buffer_load_dwordx4 v6, s[40:43], s16 offen nt lds
s_waitcnt vmcnt(4)
s_add_u32 s62, s62, s92
s_add_u32 s16, s91, s62
s_add_u32 m0, s67, 8064
s_nop 0
buffer_load_dwordx4 v6, s[40:43], s16 offen nt lds
buffer_load_dwordx4 v[96:99], v19, s[44:47], s63 offen nt
s_waitcnt vmcnt(5)
s_add_u32 s63, s63, 14336
buffer_load_dwordx4 v[100:103], v19, s[44:47], s63 offen nt
s_waitcnt vmcnt(5)
s_add_u32 s63, s63, 100352
buffer_load_dwordx4 v[104:107], v19, s[44:47], s63 offen nt
s_waitcnt vmcnt(5)
s_add_u32 s63, s63, 14336
buffer_load_dwordx4 v[108:111], v19, s[44:47], s63 offen nt
s_waitcnt vmcnt(5)
s_add_u32 s63, s63, 100352
buffer_load_dwordx4 v[112:115], v19, s[44:47], s63 offen nt
s_waitcnt vmcnt(5)
s_add_u32 s63, s63, 14336
buffer_load_dwordx4 v[116:119], v19, s[44:47], s63 offen nt
s_mov_b64 exec, 1
ds_add_u32 v2, v3 offset:16144
s_mov_b64 exec, -1
s_waitcnt vmcnt(5)
s_add_u32 s63, s63, 100352
buffer_load_dwordx4 v[120:123], v19, s[44:47], s63 offen nt
PL_3:
ds_read_b32 v60, v2 offset:16132
ds_read_b128 v[20:23], v7 offset:2048
ds_read_b128 v[24:27], v7 offset:2112
ds_read_b128 v[28:31], v7 offset:2176
ds_read_b128 v[32:35], v7 offset:2240
s_waitcnt lgkmcnt(0)
v_readfirstlane_b32 s14, v60
s_cmp_ge_u32 s14, 2
s_cbranch_scc1 PD_4
s_add_u32 s10, s10, 1
s_cmp_lt_u32 s10, 1048576
s_cbranch_scc1 PL_3
s_mov_b32 s15, 2
s_branch L_fail
T_2:
s_setpc_b64 s[94:95]
PD_4:
v_and_b32 v36, v20, v8
v_and_b32 v37, v20, v9
v_and_b32 v38, v20, v10
v_and_b32 v39, v20, v11
v_and_b32 v40, v21, v8
v_and_b32 v41, v21, v9
v_and_b32 v42, v21, v10
v_and_b32 v43, v21, v11
v_mfma_f32_16x16x32_bf16 v[52:55], v[36:39], v[96:99], 0
v_and_b32 v36, v22, v8
v_and_b32 v37, v22, v9
v_and_b32 v38, v22, v10
v_and_b32 v39, v22, v11
v_mfma_f32_16x16x32_bf16 v[56:59], v[40:43], v[96:99], 0
v_and_b32 v40, v23, v8
v_and_b32 v41, v23, v9
v_and_b32 v42, v23, v10
v_and_b32 v43, v23, v11
s_waitcnt vmcnt(5)
s_add_u32 s63, s63, 14336
buffer_load_dwordx4 v[124:127], v19, s[44:47], s63 offen nt
v_mfma_f32_16x16x32_bf16 v[52:55], v[36:39], v[100:103], v[52:55]
v_and_b32 v36, v24, v8
v_and_b32 v37, v24, v9
v_and_b32 v38, v24, v10
v_and_b32 v39, v24, v11
v_mfma_f32_16x16x32_bf16 v[56:59], v[40:43], v[100:103], v[56:59]
v_and_b32 v40, v25, v8
v_and_b32 v41, v25, v9
v_and_b32 v42, v25, v10
v_and_b32 v43, v25, v11
s_waitcnt vmcnt(4)
buffer_load_dwordx4 v[64:67], v4, s[48:51], s64 offen offset:0 nt
v_mfma_f32_16x16x32_bf16 v[52:55], v[36:39], v[104:107], v[52:55]
v_and_b32 v36, v26, v8
v_and_b32 v37, v26, v9
v_and_b32 v38, v26, v10
v_and_b32 v39, v26, v11
v_mfma_f32_16x16x32_bf16 v[56:59], v[40:43], v[104:107], v[56:59]
v_and_b32 v40, v27, v8
v_and_b32 v41, v27, v9
v_and_b32 v42, v27, v10
v_and_b32 v43, v27, v11
v_mfma_f32_16x16x32_bf16 v[52:55], v[36:39], v[108:111], v[52:55]
v_and_b32 v36, v28, v8
v_and_b32 v37, v28, v9
v_and_b32 v38, v28, v10
v_and_b32 v39, v28, v11
v_mfma_f32_16x16x32_bf16 v[56:59], v[40:43], v[108:111], v[56:59]
v_and_b32 v40, v29, v8
v_and_b32 v41, v29, v9
v_and_b32 v42, v29, v10
v_and_b32 v43, v29, v11
s_waitcnt vmcnt(4)
buffer_load_dwordx4 v[68:71], v4, s[48:51], s64 offen offset:256 nt
v_mfma_f32_16x16x32_bf16 v[52:55], v[36:39], v[112:115], v[52:55]
v_and_b32 v36, v30, v8
v_and_b32 v37, v30, v9
v_and_b32 v38, v30, v10
v_and_b32 v39, v30, v11
v_mfma_f32_16x16x32_bf16 v[56:59], v[40:43], v[112:115], v[56:59]
v_and_b32 v40, v31, v8
v_and_b32 v41, v31, v9
v_and_b32 v42, v31, v10
v_and_b32 v43, v31, v11
s_waitcnt vmcnt(4)
s_add_u32 s64, s64, 8192
buffer_load_dwordx4 v[72:75], v4, s[48:51], s64 offen offset:0 nt
v_mfma_f32_16x16x32_bf16 v[52:55], v[36:39], v[116:119], v[52:55]
v_and_b32 v36, v32, v8
v_and_b32 v37, v32, v9
v_and_b32 v38, v32, v10
v_and_b32 v39, v32, v11
v_mfma_f32_16x16x32_bf16 v[56:59], v[40:43], v[116:119], v[56:59]
v_and_b32 v40, v33, v8
v_and_b32 v41, v33, v9
v_and_b32 v42, v33, v10
v_and_b32 v43, v33, v11
s_waitcnt vmcnt(4)
buffer_load_dwordx4 v[76:79], v4, s[48:51], s64 offen offset:256 nt
v_mfma_f32_16x16x32_bf16 v[52:55], v[36:39], v[120:123], v[52:55]
v_and_b32 v36, v34, v8
v_and_b32 v37, v34, v9
v_and_b32 v38, v34, v10
v_and_b32 v39, v34, v11
v_mfma_f32_16x16x32_bf16 v[56:59], v[40:43], v[120:123], v[56:59]
v_and_b32 v40, v35, v8
v_and_b32 v41, v35, v9
v_and_b32 v42, v35, v10
v_and_b32 v43, v35, v11
s_waitcnt vmcnt(4)
s_add_u32 s64, s64, 8192
buffer_load_dwordx4 v[80:83], v4, s[48:51], s64 offen offset:0 nt
v_mfma_f32_16x16x32_bf16 v[52:55], v[36:39], v[124:127], v[52:55]
v_mfma_f32_16x16x32_bf16 v[56:59], v[40:43], v[124:127], v[56:59]
s_nop 7
v_cndmask_b32 v60, v52, v56, s[18:19]
v_cndmask_b32 v61, v53, v57, s[18:19]
v_cndmask_b32 v62, v54, v58, s[18:19]
v_cndmask_b32 v63, v55, v59, s[18:19]
v_add_f32_dpp v60, v60, v60 row_ror:8 row_mask:0xf bank_mask:0xf
v_add_f32_dpp v61, v61, v61 row_ror:8 row_mask:0xf bank_mask:0xf
v_add_f32_dpp v62, v62, v62 row_ror:8 row_mask:0xf bank_mask:0xf
v_add_f32_dpp v63, v63, v63 row_ror:8 row_mask:0xf bank_mask:0xf
s_mov_b32 exec_lo, 0x00ff00ff
s_mov_b32 exec_hi, 0x00ff00ff
ds_write_b128 v13, v[60:63] offset:6144
s_mov_b64 exec, 1
ds_add_u32 v2, v3 offset:16148
s_mov_b64 exec, -1
s_waitcnt vmcnt(4)
buffer_load_dwordx4 v[84:87], v4, s[48:51], s64 offen offset:256 nt
s_waitcnt vmcnt(4)
s_add_u32 s64, s64, 8192
buffer_load_dwordx4 v[88:91], v4, s[48:51], s64 offen offset:0 nt
s_waitcnt vmcnt(4)
buffer_load_dwordx4 v[92:95], v4, s[48:51], s64 offen offset:256 nt
s_waitcnt vmcnt(4)
buffer_load_dwordx4 v[128:131], v4, s[52:55], s65 offen offset:0 nt
s_waitcnt vmcnt(4)
buffer_load_dwordx4 v[132:135], v4, s[52:55], s65 offen offset:256 nt
s_waitcnt vmcnt(4)
s_add_u32 s65, s65, 8192
buffer_load_dwordx4 v[136:139], v4, s[52:55], s65 offen offset:0 nt
s_waitcnt vmcnt(4)
buffer_load_dwordx4 v[140:143], v4, s[52:55], s65 offen offset:256 nt
PL_5:
ds_read_b32 v60, v2 offset:16172
s_waitcnt lgkmcnt(0)
v_readfirstlane_b32 s14, v60
s_cmp_ge_u32 s14, 4
s_cbranch_scc1 PD_6
s_sleep 1
s_add_u32 s10, s10, 1
s_cmp_lt_u32 s10, 1048576
s_cbranch_scc1 PL_5
s_mov_b32 s15, 22
s_branch L_fail
T_22:
s_setpc_b64 s[94:95]
PD_6:
s_waitcnt vmcnt(4)
s_add_u32 s65, s65, 8192
buffer_load_dwordx4 v[144:147], v4, s[52:55], s65 offen offset:0 nt
s_waitcnt vmcnt(4)
buffer_load_dwordx4 v[148:151], v4, s[52:55], s65 offen offset:256 nt
s_waitcnt vmcnt(4)
s_add_u32 s65, s65, 8192
buffer_load_dwordx4 v[152:155], v4, s[52:55], s65 offen offset:0 nt
s_waitcnt vmcnt(4)
buffer_load_dwordx4 v[156:159], v4, s[52:55], s65 offen offset:256 nt
s_mul_i32 s12, s11, 0x9E3779B1
s_add_u32 s12, s12, 0x85EBCA77
s_mov_b32 s13, s12
s_mov_b32 s20, 0x07060500
s_mov_b32 s21, 0x07060501
s_mov_b32 s22, 0x07060502
s_mov_b32 s23, 0x07060503
v_mov_b32 v17, s12
PL_7:
ds_read_b32 v60, v2 offset:16160
ds_read_b128 v[20:23], v12 offset:15104
s_waitcnt lgkmcnt(0)
v_readfirstlane_b32 s14, v60
s_cmp_ge_u32 s14, 4
s_cbranch_scc1 PD_8
s_add_u32 s10, s10, 1
s_cmp_lt_u32 s10, 1048576
s_cbranch_scc1 PL_7
s_mov_b32 s15, 4
s_branch L_fail
T_4:
s_setpc_b64 s[94:95]
PD_8:
v_and_b32 v36, v20, v8
v_and_b32 v37, v20, v9
v_and_b32 v38, v20, v10
v_and_b32 v39, v20, v11
s_nop 1
v_mfma_f32_16x16x32_bf16 v[52:55], v[36:39], v[64:67], 0
v_and_b32 v40, v21, v8
v_and_b32 v41, v21, v9
v_mfma_f32_16x16x32_bf16 v[56:59], v[36:39], v[68:71], 0
v_and_b32 v42, v21, v10
v_and_b32 v43, v21, v11
s_nop 1
v_mfma_f32_16x16x32_bf16 v[52:55], v[40:43], v[72:75], v[52:55]
v_and_b32 v44, v22, v8
v_and_b32 v45, v22, v9
v_mfma_f32_16x16x32_bf16 v[56:59], v[40:43], v[76:79], v[56:59]
v_and_b32 v46, v22, v10
v_and_b32 v47, v22, v11
s_nop 1
v_mfma_f32_16x16x32_bf16 v[52:55], v[44:47], v[80:83], v[52:55]
v_and_b32 v48, v23, v8
v_and_b32 v49, v23, v9
v_mfma_f32_16x16x32_bf16 v[56:59], v[44:47], v[84:87], v[56:59]
v_and_b32 v50, v23, v10
v_and_b32 v51, v23, v11
s_nop 1
v_mfma_f32_16x16x32_bf16 v[52:55], v[48:51], v[88:91], v[52:55]
v_mfma_f32_16x16x32_bf16 v[56:59], v[48:51], v[92:95], v[56:59]
PL_9:
ds_read_b32 v60, v2 offset:16164
ds_read_b128 v[20:23], v12 offset:15616
s_waitcnt lgkmcnt(0)
v_readfirstlane_b32 s14, v60
s_cmp_ge_u32 s14, 1
s_cbranch_scc1 PD_10
s_add_u32 s10, s10, 1
s_cmp_lt_u32 s10, 1048576
s_cbranch_scc1 PL_9
s_mov_b32 s15, 3
s_branch L_fail
PD_10:
v_and_b32 v36, v20, v8
v_and_b32 v37, v20, v9
v_and_b32 v38, v20, v10
v_and_b32 v39, v20, v11
s_nop 1
v_mfma_f32_16x16x32_bf16 v[52:55], v[36:39], v[128:131], v[52:55]
v_and_b32 v40, v21, v8
v_and_b32 v41, v21, v9
v_mfma_f32_16x16x32_bf16 v[56:59], v[36:39], v[132:135], v[56:59]
v_and_b32 v42, v21, v10
v_and_b32 v43, v21, v11
s_nop 1
v_mfma_f32_16x16x32_bf16 v[52:55], v[40:43], v[136:139], v[52:55]
v_and_b32 v44, v22, v8
v_and_b32 v45, v22, v9
s_waitcnt vmcnt(4)
v_mfma_f32_16x16x32_bf16 v[56:59], v[40:43], v[140:143], v[56:59]
v_and_b32 v46, v22, v10
v_and_b32 v47, v22, v11
s_waitcnt vmcnt(3)
s_nop 0
v_mfma_f32_16x16x32_bf16 v[52:55], v[44:47], v[144:147], v[52:55]
v_and_b32 v48, v23, v8
v_and_b32 v49, v23, v9
s_waitcnt vmcnt(2)
v_mfma_f32_16x16x32_bf16 v[56:59], v[44:47], v[148:151], v[56:59]
v_and_b32 v50, v23, v10
v_and_b32 v51, v23, v11
s_waitcnt vmcnt(1)
s_nop 0
v_mfma_f32_16x16x32_bf16 v[52:55], v[48:51], v[152:155], v[52:55]
s_waitcnt vmcnt(0)
v_mfma_f32_16x16x32_bf16 v[56:59], v[48:51], v[156:159], v[56:59]
s_nop 5
ds_write_b128 v16, v[52:55] offset:16256
s_nop 0
ds_write_b128 v16, v[56:59] offset:17280
s_waitcnt lgkmcnt(0)
s_barrier
ds_read_b128 v[20:23], v15 offset:16256
ds_read_b128 v[24:27], v15 offset:18304
ds_read_b128 v[28:31], v15 offset:20352
ds_read_b128 v[32:35], v15 offset:22400
s_waitcnt lgkmcnt(0)
v_pk_add_f32 v[20:21], v[20:21], v[24:25]
v_pk_add_f32 v[22:23], v[22:23], v[26:27]
v_pk_add_f32 v[28:29], v[28:29], v[32:33]
v_pk_add_f32 v[30:31], v[30:31], v[34:35]
v_pk_add_f32 v[60:61], v[20:21], v[28:29]
v_pk_add_f32 v[62:63], v[22:23], v[30:31]
v_perm_b32 v60, v60, v17, s20
v_perm_b32 v61, v61, v17, s21
v_perm_b32 v62, v62, v17, s22
v_perm_b32 v63, v63, v17, s23
s_mov_b32 exec_hi, 0
buffer_store_dwordx4 v[60:63], v14, s[56:59], s68 offen sc1
s_mov_b64 exec, -1
s_waitcnt vmcnt(0)
s_mov_b64 exec, 1
ds_add_u32 v2, v3 offset:16176
s_mov_b64 exec, -1
s_branch L_exit
.p2align 12
L_C:
s_load_dword s11, s[56:57], 0
v_mov_b32 v15, 0xffff0000
s_cmp_eq_u32 s3, 4
s_cbranch_scc1 L_H
s_waitcnt vmcnt(1)
v_lshlrev_b32 v32, 16, v20
v_and_b32 v33, v15, v20
v_lshlrev_b32 v34, 16, v21
v_and_b32 v35, v15, v21
v_lshlrev_b32 v36, 16, v22
v_and_b32 v37, v15, v22
v_lshlrev_b32 v38, 16, v23
v_and_b32 v39, v15, v23
v_lshlrev_b32 v40, 16, v24
v_and_b32 v41, v15, v24
v_lshlrev_b32 v42, 16, v25
v_and_b32 v43, v15, v25
v_lshlrev_b32 v44, 16, v26
v_and_b32 v45, v15, v26
v_lshlrev_b32 v46, 16, v27
v_and_b32 v47, v15, v27
v_pk_add_f32 v[48:49], v[32:33], v[34:35]
v_pk_add_f32 v[50:51], v[36:37], v[38:39]
v_pk_add_f32 v[52:53], v[40:41], v[42:43]
v_pk_add_f32 v[54:55], v[44:45], v[46:47]
v_pk_add_f32 v[48:49], v[48:49], v[50:51]
v_pk_add_f32 v[52:53], v[52:53], v[54:55]
v_pk_add_f32 v[48:49], v[48:49], v[52:53]
v_add_f32 v48, v48, v49
s_nop 1
v_add_f32_dpp v48, v48, v48 quad_perm:[1,0,3,2] row_mask:0xf bank_mask:0xf
s_nop 1
v_add_f32_dpp v48, v48, v48 quad_perm:[2,3,0,1] row_mask:0xf bank_mask:0xf
s_nop 1
v_add_f32_dpp v48, v48, v48 row_half_mirror row_mask:0xf bank_mask:0xf
s_nop 1
v_add_f32_dpp v48, v48, v48 row_mirror row_mask:0xf bank_mask:0xf
s_nop 1
v_add_f32_dpp v48, v48, v48 row_bcast:15 row_mask:0xa bank_mask:0xf
s_nop 1
v_add_f32_dpp v48, v48, v48 row_bcast:31 row_mask:0xc bank_mask:0xf
s_nop 0
v_readlane_b32 s14, v48, 63
v_mov_b32 v60, 0x3a800000
s_nop 0
v_mul_f32 v48, s14, v60
v_pk_add_f32 v[52:53], v[32:33], v[48:49] op_sel_hi:[1,0] neg_lo:[0,1] neg_hi:[0,1]
v_pk_add_f32 v[54:55], v[34:35], v[48:49] op_sel_hi:[1,0] neg_lo:[0,1] neg_hi:[0,1]
v_pk_mul_f32 v[50:51], v[52:53], v[52:53]
v_pk_mul_f32 v[62:63], v[54:55], v[54:55]
v_pk_add_f32 v[52:53], v[36:37], v[48:49] op_sel_hi:[1,0] neg_lo:[0,1] neg_hi:[0,1]
v_pk_add_f32 v[54:55], v[38:39], v[48:49] op_sel_hi:[1,0] neg_lo:[0,1] neg_hi:[0,1]
v_pk_fma_f32 v[50:51], v[52:53], v[52:53], v[50:51]
v_pk_fma_f32 v[62:63], v[54:55], v[54:55], v[62:63]
v_pk_add_f32 v[52:53], v[40:41], v[48:49] op_sel_hi:[1,0] neg_lo:[0,1] neg_hi:[0,1]
v_pk_add_f32 v[54:55], v[42:43], v[48:49] op_sel_hi:[1,0] neg_lo:[0,1] neg_hi:[0,1]
v_pk_fma_f32 v[50:51], v[52:53], v[52:53], v[50:51]
v_pk_fma_f32 v[62:63], v[54:55], v[54:55], v[62:63]
v_pk_add_f32 v[52:53], v[44:45], v[48:49] op_sel_hi:[1,0] neg_lo:[0,1] neg_hi:[0,1]
v_pk_add_f32 v[54:55], v[46:47], v[48:49] op_sel_hi:[1,0] neg_lo:[0,1] neg_hi:[0,1]
v_pk_fma_f32 v[50:51], v[52:53], v[52:53], v[50:51]
v_pk_fma_f32 v[62:63], v[54:55], v[54:55], v[62:63]
v_pk_add_f32 v[50:51], v[50:51], v[62:63]
v_add_f32 v49, v50, v51
s_nop 1
v_add_f32_dpp v49, v49, v49 quad_perm:[1,0,3,2] row_mask:0xf bank_mask:0xf
s_nop 1
v_add_f32_dpp v49, v49, v49 quad_perm:[2,3,0,1] row_mask:0xf bank_mask:0xf
s_nop 1
v_add_f32_dpp v49, v49, v49 row_half_mirror row_mask:0xf bank_mask:0xf
s_nop 1
v_add_f32_dpp v49, v49, v49 row_mirror row_mask:0xf bank_mask:0xf
s_nop 1
v_add_f32_dpp v49, v49, v49 row_bcast:15 row_mask:0xa bank_mask:0xf
s_nop 1
v_add_f32_dpp v49, v49, v49 row_bcast:31 row_mask:0xc bank_mask:0xf
s_nop 0
v_readlane_b32 s14, v49, 63
s_nop 1
v_mul_f32 v49, s14, v60
v_cvt_pk_bf16_f32 v48, v48, v49
v_and_b32 v49, v15, v48
v_lshlrev_b32 v48, 16, v48
v_add_f32 v49, 0x3727c5ac, v49
v_cvt_pk_bf16_f32 v49, v49, v49
v_and_b32 v49, v15, v49
v_sqrt_f32 v49, v49
s_nop 0
v_cvt_pk_bf16_f32 v49, v49, v49
v_and_b32 v49, v15, v49
v_rcp_f32 v50, v49
s_waitcnt vmcnt(0)
v_lshlrev_b32 v56, 16, v28
v_and_b32 v57, v15, v28
v_lshlrev_b32 v58, 16, v29
v_and_b32 v59, v15, v29
v_pk_add_f32 v[56:57], v[56:57], v[48:49] op_sel_hi:[1,0] neg_lo:[0,1] neg_hi:[0,1]
v_pk_add_f32 v[58:59], v[58:59], v[48:49] op_sel_hi:[1,0] neg_lo:[0,1] neg_hi:[0,1]
v_cvt_pk_bf16_f32 v52, v56, v57
v_lshlrev_b32 v56, 16, v52
v_and_b32 v57, v15, v52
v_pk_mul_f32 v[52:53], v[56:57], v[50:51] op_sel_hi:[1,0]
v_pk_fma_f32 v[56:57], v[52:53], v[48:49], v[56:57] op_sel:[0,1,0] op_sel_hi:[1,1,1] neg_lo:[1,0,0] neg_hi:[1,0,0]
v_pk_fma_f32 v[56:57], v[56:57], v[50:51], v[52:53] op_sel_hi:[1,0,1]
v_cvt_pk_bf16_f32 v52, v58, v59
v_lshlrev_b32 v58, 16, v52
v_and_b32 v59, v15, v52
v_pk_mul_f32 v[52:53], v[58:59], v[50:51] op_sel_hi:[1,0]
v_pk_fma_f32 v[58:59], v[52:53], v[48:49], v[58:59] op_sel:[0,1,0] op_sel_hi:[1,1,1] neg_lo:[1,0,0] neg_hi:[1,0,0]
v_pk_fma_f32 v[58:59], v[58:59], v[50:51], v[52:53] op_sel_hi:[1,0,1]
s_lshl_b32 s14, s16, 10
v_add_u32 v16, s14, v4
s_cmp_ge_u32 s3, 2
s_cbranch_scc1 L_ypath
v_cvt_pk_bf16_f32 v60, v56, v56
v_cvt_pk_bf16_f32 v61, v57, v57
v_cvt_pk_bf16_f32 v62, v58, v58
v_cvt_pk_bf16_f32 v63, v59, v59
ds_write_b128 v16, v[60:63] offset:0
s_mov_b64 exec, 1
ds_add_u32 v2, v3 offset:16128
s_mov_b64 exec, -1
s_cmp_eq_u32 s3, 0
s_cbranch_scc1 L_t0
s_call_b64 s[94:95], T_9
s_call_b64 s[94:95], T_13
s_call_b64 s[94:95], T_22
s_call_b64 s[94:95], T_4
s_branch L_lndone
L_t0:
s_call_b64 s[94:95], T_19
s_call_b64 s[94:95], T_8
s_call_b64 s[94:95], T_11
s_call_b64 s[94:95], T_2
L_lndone:
s_waitcnt lgkmcnt(0)
s_mul_i32 s12, s11, 0x9E3779B1
s_add_u32 s12, s12, 0x85EBCA77
s_mov_b32 s13, s12
s_mov_b32 s20, 0x07060500
s_mov_b32 s21, 0x07060501
s_mov_b32 s22, 0x07060502
s_mov_b32 s23, 0x07060503
v_mov_b32 v5, s12
v_and_b32 v6, 0xff, v5
v_bfe_u32 v7, v5, 8, 8
v_bfe_u32 v8, v5, 16, 8
v_lshrrev_b32 v9, 24, v5
v_and_b32 v16, 15, v1
v_lshrrev_b32 v17, 4, v1
v_lshrrev_b32 v18, 2, v16
v_and_b32 v19, 3, v1
v_mul_u32_u24 v52, 1088, v18
v_lshl_add_u32 v52, v19, 8, v52
v_xor_b32 v20, v17, v19
v_lshl_add_u32 v52, v20, 4, v52
s_mul_i32 s14, s3, 8704
v_add_u32 v52, s14, v52
v_lshrrev_b32 v20, 5, v1
v_mul_u32_u24 v20, 288, v20
v_and_b32 v21, 31, v1
v_lshl_add_u32 v53, v21, 3, v20
s_mul_i32 s14, s3, 576
v_add_u32 v53, s14, v53
v_and_b32 v20, 7, v1
v_mul_u32_u24 v20, 288, v20
v_lshl_add_u32 v54, v17, 4, v20
v_mul_u32_u24 v20, 1152, v17
v_lshl_add_u32 v20, v18, 8, v20
v_and_b32 v21, 1, v1
v_lshl_add_u32 v20, v21, 3, v20
v_add_u32 v20, 51072, v20
v_bfe_u32 v21, v1, 1, 1
s_lshl_b32 s14, s3, 2
v_add_u32 v21, s14, v21
v_lshlrev_b32 v22, 1, v18
v_xor_b32 v21, v21, v22
v_lshl_add_u32 v55, v21, 4, v20
v_xor_b32 v21, 2, v21
v_lshl_add_u32 v56, v21, 4, v20
v_lshlrev_b32 v57, 3, v16
v_and_b32 v20, 0x37, v1
v_lshlrev_b32 v13, 4, v20
v_and_b32 v21, 8, v1
v_add_u32 v58, v13, v21
s_lshl_b32 s14, s3, 10
v_add_u32 v58, s14, v58
s_lshl_b32 s14, s3, 7
v_add_u32 v59, s14, v57
v_and_b32 v20, 7, v1
v_bfe_u32 v21, v1, 3, 1
v_lshlrev_b32 v60, 14, v20
v_lshl_add_u32 v60, v21, 6, v60
v_lshl_add_u32 v60, v17, 4, v60
v_lshlrev_b32 v61, 10, v20
v_lshlrev_b32 v62, 7, v1
v_lshrrev_b32 v63, 3, v1
v_lshlrev_b32 v63, 3, v63
v_bfe_u32 v14, v1, 2, 1
v_lshl_add_u32 v14, v14, 2, v17
v_lshl_add_u32 v14, v14, 2, v19
v_lshlrev_b32 v14, 2, v14
v_add_u32 v14, s14, v14
s_lshl_b32 s14, s4, 5
s_add_u32 s14, s14, s3
s_lshl_b32 s28, s14, 12
s_lshl_b32 s17, s5, 7
s_add_u32 s28, s28, s17
s_add_u32 s28, s28, 1048576
s_lshl_b32 s29, s14, 8
s_lshl_b32 s17, s5, 3
s_add_u32 s29, s29, s17
s_add_u32 s29, s29, 98304
s_lshl_b32 s31, s4, 2
s_add_u32 s31, s31, s3
s_lshl_b32 s31, s31, 9
s_lshr_b32 s17, s5, 4
s_lshl_b32 s17, s17, 6
s_add_u32 s31, s31, s17
s_and_b32 s17, s5, 15
s_lshl_b32 s17, s17, 2
s_add_u32 s31, s31, s17
s_add_u32 s31, s31, 32768
s_mov_b32 s18, 0xff00ff00
s_mov_b32 s19, 0xff00ff00
v_mov_b32 v48, 0x3db504f3
v_mov_b32 v50, 0x3fb8aa3b
s_call_b64 s[94:95], L_oaddr
PL_11:
ds_read_b32 v32, v2 offset:16140
s_waitcnt lgkmcnt(0)
v_readfirstlane_b32 s14, v32
s_cmp_ge_u32 s14, 4
s_cbranch_scc1 PD_12
s_sleep 2
s_add_u32 s10, s10, 1
s_cmp_lt_u32 s10, 1048576
s_cbranch_scc1 PL_11
s_mov_b32 s15, 19
s_branch L_fail
T_19:
s_setpc_b64 s[94:95]
PD_12:
HL_14:
s_load_dwordx16 s[64:79], s[60:61], 0 glc
s_waitcnt lgkmcnt(0)
s_cmp_eq_u64 s[64:65], s[12:13]
s_cbranch_scc0 HR_16
s_cmp_eq_u64 s[66:67], s[12:13]
s_cbranch_scc0 HR_16
s_cmp_eq_u64 s[68:69], s[12:13]
s_cbranch_scc0 HR_16
s_cmp_eq_u64 s[70:71], s[12:13]
s_cbranch_scc0 HR_16
s_cmp_eq_u64 s[72:73], s[12:13]
s_cbranch_scc0 HR_16
s_cmp_eq_u64 s[74:75], s[12:13]
s_cbranch_scc0 HR_16
s_cmp_eq_u64 s[76:77], s[12:13]
s_cbranch_scc0 HR_16
s_cmp_eq_u64 s[78:79], s[12:13]
s_cbranch_scc0 HR_16
s_branch HD_15
HR_16:
s_add_u32 s10, s10, 1
s_cmp_lt_u32 s10, 1048576
s_cbranch_scc1 HL_14
s_mov_b32 s15, 6
s_branch L_fail
HD_15:
GQ_13:
buffer_load_dwordx4 v[16:19], v4, s[56:59], s62 offen offset:0 sc1
buffer_load_dwordx4 v[20:23], v4, s[56:59], s62 offen offset:1024 sc1
buffer_load_dwordx4 v[24:27], v4, s[56:59], s62 offen offset:2048 sc1
buffer_load_dwordx4 v[28:31], v4, s[56:59], s62 offen offset:3072 sc1
PL_17:
ds_read_b32 v32, v2 offset:16140
ds_read_b128 v[64:67], v52 offset:16256
ds_read_b128 v[68:71], v52 offset:16320
ds_read_b128 v[72:75], v52 offset:16384
ds_read_b128 v[76:79], v52 offset:16448
ds_read_b128 v[80:83], v52 offset:20608
ds_read_b128 v[84:87], v52 offset:20672
ds_read_b128 v[88:91], v52 offset:20736
ds_read_b128 v[92:95], v52 offset:20800
s_waitcnt lgkmcnt(0)
v_readfirstlane_b32 s14, v32
s_cmp_ge_u32 s14, 4
s_cbranch_scc1 PD_18
s_add_u32 s10, s10, 1
s_cmp_lt_u32 s10, 1048576
s_cbranch_scc1 PL_17
s_mov_b32 s15, 7
s_branch L_fail
PD_18:
s_waitcnt vmcnt(0)
ds_read_b32 v33, v2 offset:16144
v_xor_b32 v16, v16, v6
v_xor_b32 v17, v17, v7
v_xor_b32 v18, v18, v8
v_xor_b32 v19, v19, v9
v_xor_b32 v20, v20, v6
v_xor_b32 v21, v21, v7
v_xor_b32 v22, v22, v8
v_xor_b32 v23, v23, v9
v_xor_b32 v24, v24, v6
v_xor_b32 v25, v25, v7
v_xor_b32 v26, v26, v8
v_xor_b32 v27, v27, v9
v_xor_b32 v28, v28, v6
v_xor_b32 v29, v29, v7
v_xor_b32 v30, v30, v8
v_xor_b32 v31, v31, v9
v_pk_add_f32 v[36:37], v[16:17], v[20:21]
v_pk_add_f32 v[38:39], v[18:19], v[22:23]
v_pk_add_f32 v[40:41], v[24:25], v[28:29]
v_pk_add_f32 v[42:43], v[26:27], v[30:31]
v_pk_add_f32 v[36:37], v[36:37], v[40:41]
v_pk_add_f32 v[38:39], v[38:39], v[42:43]
v_cvt_pk_bf16_f32 v36, v36, v37
v_cvt_pk_bf16_f32 v37, v38, v39
ds_write_b64 v53, v[36:37] offset:8192
v_or3_b32 v32, v16, v17, v18
v_or3_b32 v34, v19, v20, v21
v_or3_b32 v32, v32, v22, v23
v_or3_b32 v34, v34, v24, v25
v_or3_b32 v32, v32, v26, v27
v_or3_b32 v34, v34, v28, v29
v_or3_b32 v32, v32, v30, v31
v_or_b32 v32, v32, v34
v_lshlrev_b32 v32, 24, v32
v_cmp_ne_u32 vcc, 0, v32
s_cbranch_vccz RD_19
s_add_u32 s10, s10, 1
s_cmp_lt_u32 s10, 1048576
s_cbranch_scc1 GQ_13
s_mov_b32 s15, 8
s_branch L_fail
T_8:
s_setpc_b64 s[94:95]
RD_19:
s_mov_b64 exec, 1
ds_add_u32 v2, v3 offset:16152
s_mov_b64 exec, -1
PL_20:
ds_read_b32 v32, v2 offset:16152
ds_read_b128 v[128:131], v54 offset:8192
ds_read_b128 v[132:135], v54 offset:8256
ds_read_b128 v[136:139], v54 offset:8320
ds_read_b128 v[140:143], v54 offset:8384
s_waitcnt lgkmcnt(0)
v_readfirstlane_b32 s14, v32
s_cmp_ge_u32 s14, 4
s_cbranch_scc1 PD_21
s_add_u32 s10, s10, 1
s_cmp_lt_u32 s10, 1048576
s_cbranch_scc1 PL_20
s_mov_b32 s15, 9
s_branch L_fail
T_9:
s_setpc_b64 s[94:95]
PD_21:
v_mfma_f32_16x16x32_bf16 v[40:43], v[64:67], v[128:131], 0
v_mfma_f32_16x16x32_bf16 v[44:47], v[80:83], v[128:131], 0
v_mfma_f32_16x16x32_bf16 v[40:43], v[68:71], v[132:135], v[40:43]
v_mfma_f32_16x16x32_bf16 v[44:47], v[84:87], v[132:135], v[44:47]
v_mfma_f32_16x16x32_bf16 v[40:43], v[72:75], v[136:139], v[40:43]
v_mfma_f32_16x16x32_bf16 v[44:47], v[88:91], v[136:139], v[44:47]
v_mfma_f32_16x16x32_bf16 v[40:43], v[76:79], v[140:143], v[40:43]
v_mfma_f32_16x16x32_bf16 v[44:47], v[92:95], v[140:143], v[44:47]
v_readfirstlane_b32 s35, v33
s_cmp_lt_u32 s35, 4
s_cbranch_scc1 L_vlater
ds_read_b64_tr_b16 v[96:97], v55 offset:0
ds_read_b64_tr_b16 v[98:99], v55 offset:4608
ds_read_b64_tr_b16 v[100:101], v56 offset:0
ds_read_b64_tr_b16 v[102:103], v56 offset:4608
ds_read_b64_tr_b16 v[104:105], v55 offset:9216
ds_read_b64_tr_b16 v[106:107], v55 offset:13824
ds_read_b64_tr_b16 v[108:109], v56 offset:9216
ds_read_b64_tr_b16 v[110:111], v56 offset:13824
ds_read_b64_tr_b16 v[112:113], v55 offset:18432
ds_read_b64_tr_b16 v[114:115], v55 offset:23040
ds_read_b64_tr_b16 v[116:117], v56 offset:18432
ds_read_b64_tr_b16 v[118:119], v56 offset:23040
ds_read_b64_tr_b16 v[120:121], v55 offset:27648
ds_read_b64_tr_b16 v[122:123], v55 offset:32256
ds_read_b64_tr_b16 v[124:125], v56 offset:27648
ds_read_b64_tr_b16 v[126:127], v56 offset:32256
L_vlater:
s_nop 7
v_cndmask_b32 v40, v40, v44, s[18:19]
v_cndmask_b32 v41, v41, v45, s[18:19]
v_cndmask_b32 v42, v42, v46, s[18:19]
v_cndmask_b32 v43, v43, v47, s[18:19]
v_cvt_pk_bf16_f32 v32, v40, v41
v_cvt_pk_bf16_f32 v33, v42, v43
v_lshlrev_b32 v40, 16, v32
v_and_b32 v41, v15, v32
v_lshlrev_b32 v42, 16, v33
v_and_b32 v43, v15, v33
v_pk_mul_f32 v[40:41], v[40:41], v[48:49] op_sel_hi:[1,0]
v_pk_mul_f32 v[42:43], v[42:43], v[48:49] op_sel_hi:[1,0]
v_cvt_pk_bf16_f32 v32, v40, v41
v_cvt_pk_bf16_f32 v33, v42, v43
v_lshlrev_b32 v40, 16, v32
v_and_b32 v41, v15, v32
v_lshlrev_b32 v42, 16, v33
v_and_b32 v43, v15, v33
v_max3_f32 v32, v40, v41, v42
v_max_f32 v32, v32, v43
v_pk_mul_f32 v[40:41], v[40:41], v[50:51] op_sel_hi:[1,0]
v_pk_mul_f32 v[42:43], v[42:43], v[50:51] op_sel_hi:[1,0]
v_max_f32_dpp v32, v32, v32 row_ror:8 row_mask:0xf bank_mask:0xf
v_mov_b32 v33, v32
s_nop 1
v_permlane16_swap_b32 v32, v33
v_max_f32 v32, v32, v33
v_mov_b32 v33, v32
s_nop 1
v_permlane32_swap_b32 v32, v33
v_max_f32 v32, v32, v33
v_mul_f32 v32, v50, v32
v_pk_add_f32 v[40:41], v[40:41], v[32:33] op_sel_hi:[1,0] neg_lo:[0,1] neg_hi:[0,1]
v_pk_add_f32 v[42:43], v[42:43], v[32:33] op_sel_hi:[1,0] neg_lo:[0,1] neg_hi:[0,1]
v_exp_f32 v40, v40
v_exp_f32 v41, v41
v_exp_f32 v42, v42
v_exp_f32 v43, v43
s_nop 0
v_pk_add_f32 v[34:35], v[40:41], v[42:43]
v_cvt_pk_bf16_f32 v36, v40, v41
v_add_f32 v33, v34, v35
v_cvt_pk_bf16_f32 v37, v42, v43
ds_write_b64 v58, v[36:37] offset:10496
v_add_f32_dpp v33, v33, v33 row_ror:8 row_mask:0xf bank_mask:0xf
v_mov_b32 v35, v33
s_nop 1
v_permlane16_swap_b32 v33, v35
v_add_f32 v33, v33, v35
v_mov_b32 v35, v33
s_nop 1
v_permlane32_swap_b32 v33, v35
v_add_f32 v33, v33, v35
ds_write_b64 v59, v[32:33] offset:14592
s_mov_b64 exec, 1
ds_add_u32 v2, v3 offset:16156
s_mov_b64 exec, -1
s_cmp_ge_u32 s35, 4
s_cbranch_scc1 L_vdone
PL_22:
ds_read_b32 v32, v2 offset:16144
s_waitcnt lgkmcnt(0)
v_readfirstlane_b32 s14, v32
s_cmp_ge_u32 s14, 4
s_cbranch_scc1 PD_23
s_add_u32 s10, s10, 1
s_cmp_lt_u32 s10, 1048576
s_cbranch_scc1 PL_22
s_mov_b32 s15, 10
s_branch L_fail
PD_23:
ds_read_b64_tr_b16 v[96:97], v55 offset:0
ds_read_b64_tr_b16 v[98:99], v55 offset:4608
ds_read_b64_tr_b16 v[100:101], v56 offset:0
ds_read_b64_tr_b16 v[102:103], v56 offset:4608
ds_read_b64_tr_b16 v[104:105], v55 offset:9216
ds_read_b64_tr_b16 v[106:107], v55 offset:13824
ds_read_b64_tr_b16 v[108:109], v56 offset:9216
ds_read_b64_tr_b16 v[110:111], v56 offset:13824
ds_read_b64_tr_b16 v[112:113], v55 offset:18432
ds_read_b64_tr_b16 v[114:115], v55 offset:23040
ds_read_b64_tr_b16 v[116:117], v56 offset:18432
ds_read_b64_tr_b16 v[118:119], v56 offset:23040
ds_read_b64_tr_b16 v[120:121], v55 offset:27648
ds_read_b64_tr_b16 v[122:123], v55 offset:32256
ds_read_b64_tr_b16 v[124:125], v56 offset:27648
ds_read_b64_tr_b16 v[126:127], v56 offset:32256
L_vdone:
PL_24:
ds_read_b32 v40, v2 offset:16156
ds_read_b128 v[16:19], v13 offset:10496
ds_read_b128 v[20:23], v13 offset:11520
ds_read_b128 v[24:27], v13 offset:12544
ds_read_b128 v[28:31], v13 offset:13568
ds_read_b64 v[32:33], v57 offset:14592
ds_read_b64 v[34:35], v57 offset:14720
ds_read_b64 v[36:37], v57 offset:14848
ds_read_b64 v[38:39], v57 offset:14976
s_waitcnt lgkmcnt(0)
v_readfirstlane_b32 s14, v40
s_cmp_ge_u32 s14, 4
s_cbranch_scc1 PD_25
s_add_u32 s10, s10, 1
s_cmp_lt_u32 s10, 1048576
s_cbranch_scc1 PL_24
s_mov_b32 s15, 11
s_branch L_fail
T_11:
s_setpc_b64 s[94:95]
PD_25:
v_mfma_f32_16x16x32_bf16 v[128:131], v[96:99], v[16:19], 0
v_max3_f32 v41, v32, v34, v36
v_max_f32 v41, v41, v38
v_mfma_f32_16x16x32_bf16 v[132:135], v[100:103], v[16:19], 0
v_sub_f32 v40, v32, v41
v_sub_f32 v42, v34, v41
v_mfma_f32_16x16x32_bf16 v[136:139], v[104:107], v[20:23], 0
v_sub_f32 v44, v36, v41
v_sub_f32 v46, v38, v41
v_mfma_f32_16x16x32_bf16 v[140:143], v[108:111], v[20:23], 0
v_exp_f32 v40, v40
v_mfma_f32_16x16x32_bf16 v[144:147], v[112:115], v[24:27], 0
v_exp_f32 v42, v42
v_mfma_f32_16x16x32_bf16 v[148:151], v[116:119], v[24:27], 0
v_exp_f32 v44, v44
v_mfma_f32_16x16x32_bf16 v[152:155], v[120:123], v[28:31], 0
v_exp_f32 v46, v46
v_mfma_f32_16x16x32_bf16 v[156:159], v[124:127], v[28:31], 0
v_mul_f32 v43, v40, v33
v_fmac_f32 v43, v42, v35
v_fmac_f32 v43, v44, v37
v_fmac_f32 v43, v46, v39
v_cndmask_b32 v128, v128, v132, s[18:19]
v_cndmask_b32 v129, v129, v133, s[18:19]
v_cndmask_b32 v130, v130, v134, s[18:19]
v_cndmask_b32 v131, v131, v135, s[18:19]
v_rcp_f32 v48, v43
v_log_f32 v43, v43
v_cndmask_b32 v136, v136, v140, s[18:19]
v_cndmask_b32 v137, v137, v141, s[18:19]
v_cndmask_b32 v138, v138, v142, s[18:19]
v_cndmask_b32 v139, v139, v143, s[18:19]
v_cndmask_b32 v144, v144, v148, s[18:19]
v_cndmask_b32 v145, v145, v149, s[18:19]
v_cndmask_b32 v146, v146, v150, s[18:19]
v_cndmask_b32 v147, v147, v151, s[18:19]
v_cndmask_b32 v152, v152, v156, s[18:19]
v_cndmask_b32 v153, v153, v157, s[18:19]
v_cndmask_b32 v154, v154, v158, s[18:19]
v_cndmask_b32 v155, v155, v159, s[18:19]
v_pk_mul_f32 v[16:17], v[128:129], v[40:41] op_sel_hi:[1,0]
v_pk_mul_f32 v[18:19], v[130:131], v[40:41] op_sel_hi:[1,0]
v_pk_fma_f32 v[16:17], v[136:137], v[42:43], v[16:17] op_sel_hi:[1,0,1]
v_pk_fma_f32 v[18:19], v[138:139], v[42:43], v[18:19] op_sel_hi:[1,0,1]
v_pk_fma_f32 v[16:17], v[144:145], v[44:45], v[16:17] op_sel_hi:[1,0,1]
v_pk_fma_f32 v[18:19], v[146:147], v[44:45], v[18:19] op_sel_hi:[1,0,1]
v_pk_fma_f32 v[16:17], v[152:153], v[46:47], v[16:17] op_sel_hi:[1,0,1]
v_pk_fma_f32 v[18:19], v[154:155], v[46:47], v[18:19] op_sel_hi:[1,0,1]
v_pk_mul_f32 v[16:17], v[16:17], v[48:49] op_sel_hi:[1,0]
v_pk_mul_f32 v[18:19], v[18:19], v[48:49] op_sel_hi:[1,0]
v_perm_b32 v16, v16, v5, s20
v_perm_b32 v17, v17, v5, s21
v_perm_b32 v18, v18, v5, s22
v_perm_b32 v19, v19, v5, s23
buffer_store_dwordx4 v[16:19], v60, s[56:59], s28 offen sc1
v_add_f32 v46, v41, v43
v_mov_b32 v47, v5
s_mov_b64 exec, 0xff
buffer_atomic_swap_x2 v[46:47], v61, s[56:59], s29 offen sc1
s_mov_b32 exec_lo, 0xf
buffer_atomic_swap v5, v62, s[56:59], s31 offen sc1
s_mov_b64 exec, -1
s_mov_b32 s60, s36
s_mov_b32 s61, s37
s_waitcnt vmcnt(0)
HL_26:
s_load_dwordx16 s[64:79], s[60:61], 0 glc
s_load_dwordx16 s[80:95], s[60:61], 64 glc
s_waitcnt lgkmcnt(0)
s_cmp_eq_u64 s[64:65], s[12:13]
s_cbranch_scc0 HR_28
s_cmp_eq_u64 s[66:67], s[12:13]
s_cbranch_scc0 HR_28
s_cmp_eq_u64 s[68:69], s[12:13]
s_cbranch_scc0 HR_28
s_cmp_eq_u64 s[70:71], s[12:13]
s_cbranch_scc0 HR_28
s_cmp_eq_u64 s[72:73], s[12:13]
s_cbranch_scc0 HR_28
s_cmp_eq_u64 s[74:75], s[12:13]
s_cbranch_scc0 HR_28
s_cmp_eq_u64 s[76:77], s[12:13]
s_cbranch_scc0 HR_28
s_cmp_eq_u64 s[78:79], s[12:13]
s_cbranch_scc0 HR_28
s_cmp_eq_u64 s[80:81], s[12:13]
s_cbranch_scc0 HR_28
s_cmp_eq_u64 s[82:83], s[12:13]
s_cbranch_scc0 HR_28
s_cmp_eq_u64 s[84:85], s[12:13]
s_cbranch_scc0 HR_28
s_cmp_eq_u64 s[86:87], s[12:13]
s_cbranch_scc0 HR_28
s_cmp_eq_u64 s[88:89], s[12:13]
s_cbranch_scc0 HR_28
s_cmp_eq_u64 s[90:91], s[12:13]
s_cbranch_scc0 HR_28
s_cmp_eq_u64 s[92:93], s[12:13]
s_cbranch_scc0 HR_28
s_cmp_eq_u64 s[94:95], s[12:13]
s_cbranch_scc0 HR_28
s_branch HD_27
HR_28:
s_add_u32 s10, s10, 1
s_cmp_lt_u32 s10, 1048576
s_cbranch_scc1 HL_26
s_mov_b32 s15, 13
s_branch L_fail
T_13:
s_setpc_b64 s[94:95]
HD_27:
s_mov_b64 vcc, -1
GO_29:
buffer_load_dwordx2 v[32:33], v63, s[56:59], s39 offen offset:0 sc1
buffer_load_dwordx2 v[34:35], v63, s[56:59], s39 offen offset:64 sc1
buffer_load_dwordx2 v[36:37], v63, s[56:59], s39 offen offset:128 sc1
buffer_load_dwordx2 v[38:39], v63, s[56:59], s39 offen offset:192 sc1
s_mov_b64 exec, vcc
buffer_load_dwordx4 v[16:19], v4, s[56:59], s38 offen offset:0 sc1
buffer_load_dwordx4 v[20:23], v4, s[56:59], s38 offen offset:1024 sc1
buffer_load_dwordx4 v[24:27], v4, s[56:59], s38 offen offset:2048 sc1
buffer_load_dwordx4 v[28:31], v4, s[56:59], s38 offen offset:3072 sc1
s_mov_b64 exec, 1
ds_add_u32 v2, v3 offset:16172
s_mov_b64 exec, -1
s_waitcnt vmcnt(4)
v_max3_f32 v40, v32, v34, v36
v_max_f32 v40, v40, v38
v_xor_b32 v41, v33, v5
v_bitop3_b32 v41, v41, v35, v5 bitop3:0xf6
v_max_f32_dpp v40, v40, v40 row_ror:8 row_mask:0xf bank_mask:0xf
v_mov_b32 v42, v40
v_bitop3_b32 v41, v41, v37, v5 bitop3:0xf6
v_bitop3_b32 v41, v41, v39, v5 bitop3:0xf6
v_permlane16_swap_b32 v40, v42
v_max_f32 v40, v40, v42
v_mov_b32 v42, v40
s_nop 1
v_permlane32_swap_b32 v40, v42
v_max_f32 v40, v40, v42
v_sub_f32 v32, v32, v40
v_sub_f32 v34, v34, v40
v_sub_f32 v36, v36, v40
v_sub_f32 v38, v38, v40
v_exp_f32 v32, v32
v_exp_f32 v34, v34
v_exp_f32 v36, v36
v_exp_f32 v38, v38
s_waitcnt vmcnt(0)
v_add_f32 v43, v32, v34
v_add_f32 v42, v36, v38
v_add_f32 v43, v43, v42
v_xor_b32 v16, v16, v6
v_xor_b32 v17, v17, v7
v_add_f32_dpp v43, v43, v43 row_ror:8 row_mask:0xf bank_mask:0xf
v_mov_b32 v42, v43
v_xor_b32 v18, v18, v8
v_xor_b32 v19, v19, v9
v_xor_b32 v20, v20, v6
v_xor_b32 v21, v21, v7
v_permlane16_swap_b32 v43, v42
v_add_f32 v43, v43, v42
v_mov_b32 v42, v43
v_xor_b32 v22, v22, v8
v_xor_b32 v23, v23, v9
v_xor_b32 v24, v24, v6
v_xor_b32 v25, v25, v7
v_permlane32_swap_b32 v43, v42
v_add_f32 v43, v43, v42
v_rcp_f32 v43, v43
v_xor_b32 v26, v26, v8
v_xor_b32 v27, v27, v9
v_xor_b32 v28, v28, v6
v_xor_b32 v29, v29, v7
v_xor_b32 v30, v30, v8
v_xor_b32 v31, v31, v9
v_pk_mul_f32 v[44:45], v[16:17], v[32:33] op_sel_hi:[1,0]
v_pk_mul_f32 v[46:47], v[18:19], v[32:33] op_sel_hi:[1,0]
v_pk_fma_f32 v[44:45], v[20:21], v[34:35], v[44:45] op_sel_hi:[1,0,1]
v_pk_fma_f32 v[46:47], v[22:23], v[34:35], v[46:47] op_sel_hi:[1,0,1]
v_pk_fma_f32 v[44:45], v[24:25], v[36:37], v[44:45] op_sel_hi:[1,0,1]
v_pk_fma_f32 v[46:47], v[26:27], v[36:37], v[46:47] op_sel_hi:[1,0,1]
v_pk_fma_f32 v[44:45], v[28:29], v[38:39], v[44:45] op_sel_hi:[1,0,1]
v_pk_fma_f32 v[46:47], v[30:31], v[38:39], v[46:47] op_sel_hi:[1,0,1]
v_or3_b32 v42, v16, v17, v18
v_or3_b32 v42, v42, v19, v20
v_permlane32_swap_b32 v44, v46
v_permlane32_swap_b32 v45, v47
v_add_f32 v44, v44, v46
v_add_f32 v45, v45, v47
v_or3_b32 v42, v42, v21, v22
v_or3_b32 v42, v42, v23, v24
v_permlane16_swap_b32 v44, v45
v_add_f32 v44, v44, v45
v_or3_b32 v42, v42, v25, v26
v_or3_b32 v42, v42, v27, v28
v_add_f32_dpp v44, v44, v44 row_ror:8 row_mask:0xf bank_mask:0xf
v_or3_b32 v42, v42, v29, v30
v_or_b32 v42, v42, v31
v_lshl_or_b32 v42, v42, 24, v41
v_mul_f32 v44, v44, v43
v_cvt_pk_bf16_f32 v44, v44, v44
v_cmp_ne_u32 vcc, 0, v42
s_cbranch_vccnz L_oretry
ds_write_b32 v14, v44 offset:15104
s_mov_b64 exec, 1
ds_add_u32 v2, v3 offset:16160
s_mov_b64 exec, -1
s_branch L_exit
.p2align 12
T_y:
s_setpc_b64 s[94:95]
L_ypath:
v_cvt_pk_bf16_f32 v52, v56, v57
v_lshlrev_b32 v56, 16, v52
v_and_b32 v57, v15, v52
v_cvt_pk_bf16_f32 v52, v58, v59
v_lshlrev_b32 v58, 16, v52
v_and_b32 v59, v15, v52
v_pk_add_f32 v[32:33], v[32:33], v[48:49] op_sel_hi:[1,0] neg_lo:[0,1] neg_hi:[0,1]
v_pk_add_f32 v[34:35], v[34:35], v[48:49] op_sel_hi:[1,0] neg_lo:[0,1] neg_hi:[0,1]
v_pk_add_f32 v[36:37], v[36:37], v[48:49] op_sel_hi:[1,0] neg_lo:[0,1] neg_hi:[0,1]
v_pk_add_f32 v[38:39], v[38:39], v[48:49] op_sel_hi:[1,0] neg_lo:[0,1] neg_hi:[0,1]
v_pk_add_f32 v[40:41], v[40:41], v[48:49] op_sel_hi:[1,0] neg_lo:[0,1] neg_hi:[0,1]
v_pk_add_f32 v[42:43], v[42:43], v[48:49] op_sel_hi:[1,0] neg_lo:[0,1] neg_hi:[0,1]
v_pk_add_f32 v[44:45], v[44:45], v[48:49] op_sel_hi:[1,0] neg_lo:[0,1] neg_hi:[0,1]
v_pk_add_f32 v[46:47], v[46:47], v[48:49] op_sel_hi:[1,0] neg_lo:[0,1] neg_hi:[0,1]
v_cvt_pk_bf16_f32 v52, v32, v33
v_lshlrev_b32 v32, 16, v52
v_and_b32 v33, v15, v52
v_pk_mul_f32 v[52:53], v[32:33], v[50:51] op_sel_hi:[1,0]
v_pk_fma_f32 v[32:33], v[52:53], v[48:49], v[32:33] op_sel:[0,1,0] op_sel_hi:[1,1,1] neg_lo:[1,0,0] neg_hi:[1,0,0]
v_pk_fma_f32 v[32:33], v[32:33], v[50:51], v[52:53] op_sel_hi:[1,0,1]
v_cvt_pk_bf16_f32 v52, v34, v35
v_lshlrev_b32 v34, 16, v52
v_and_b32 v35, v15, v52
v_pk_mul_f32 v[52:53], v[34:35], v[50:51] op_sel_hi:[1,0]
v_pk_fma_f32 v[34:35], v[52:53], v[48:49], v[34:35] op_sel:[0,1,0] op_sel_hi:[1,1,1] neg_lo:[1,0,0] neg_hi:[1,0,0]
v_pk_fma_f32 v[34:35], v[34:35], v[50:51], v[52:53] op_sel_hi:[1,0,1]
v_cvt_pk_bf16_f32 v52, v36, v37
v_lshlrev_b32 v36, 16, v52
v_and_b32 v37, v15, v52
v_pk_mul_f32 v[52:53], v[36:37], v[50:51] op_sel_hi:[1,0]
v_pk_fma_f32 v[36:37], v[52:53], v[48:49], v[36:37] op_sel:[0,1,0] op_sel_hi:[1,1,1] neg_lo:[1,0,0] neg_hi:[1,0,0]
v_pk_fma_f32 v[36:37], v[36:37], v[50:51], v[52:53] op_sel_hi:[1,0,1]
v_cvt_pk_bf16_f32 v52, v38, v39
v_lshlrev_b32 v38, 16, v52
v_and_b32 v39, v15, v52
v_pk_mul_f32 v[52:53], v[38:39], v[50:51] op_sel_hi:[1,0]
v_pk_fma_f32 v[38:39], v[52:53], v[48:49], v[38:39] op_sel:[0,1,0] op_sel_hi:[1,1,1] neg_lo:[1,0,0] neg_hi:[1,0,0]
v_pk_fma_f32 v[38:39], v[38:39], v[50:51], v[52:53] op_sel_hi:[1,0,1]
v_cvt_pk_bf16_f32 v52, v40, v41
v_lshlrev_b32 v40, 16, v52
v_and_b32 v41, v15, v52
v_pk_mul_f32 v[52:53], v[40:41], v[50:51] op_sel_hi:[1,0]
v_pk_fma_f32 v[40:41], v[52:53], v[48:49], v[40:41] op_sel:[0,1,0] op_sel_hi:[1,1,1] neg_lo:[1,0,0] neg_hi:[1,0,0]
v_pk_fma_f32 v[40:41], v[40:41], v[50:51], v[52:53] op_sel_hi:[1,0,1]
v_cvt_pk_bf16_f32 v52, v42, v43
v_lshlrev_b32 v42, 16, v52
v_and_b32 v43, v15, v52
v_pk_mul_f32 v[52:53], v[42:43], v[50:51] op_sel_hi:[1,0]
v_pk_fma_f32 v[42:43], v[52:53], v[48:49], v[42:43] op_sel:[0,1,0] op_sel_hi:[1,1,1] neg_lo:[1,0,0] neg_hi:[1,0,0]
v_pk_fma_f32 v[42:43], v[42:43], v[50:51], v[52:53] op_sel_hi:[1,0,1]
v_cvt_pk_bf16_f32 v52, v44, v45
v_lshlrev_b32 v44, 16, v52
v_and_b32 v45, v15, v52
v_pk_mul_f32 v[52:53], v[44:45], v[50:51] op_sel_hi:[1,0]
v_pk_fma_f32 v[44:45], v[52:53], v[48:49], v[44:45] op_sel:[0,1,0] op_sel_hi:[1,1,1] neg_lo:[1,0,0] neg_hi:[1,0,0]
v_pk_fma_f32 v[44:45], v[44:45], v[50:51], v[52:53] op_sel_hi:[1,0,1]
v_cvt_pk_bf16_f32 v52, v46, v47
v_lshlrev_b32 v46, 16, v52
v_and_b32 v47, v15, v52
v_pk_mul_f32 v[52:53], v[46:47], v[50:51] op_sel_hi:[1,0]
v_pk_fma_f32 v[46:47], v[52:53], v[48:49], v[46:47] op_sel:[0,1,0] op_sel_hi:[1,1,1] neg_lo:[1,0,0] neg_hi:[1,0,0]
v_pk_fma_f32 v[46:47], v[46:47], v[50:51], v[52:53] op_sel_hi:[1,0,1]
v_cvt_pk_bf16_f32 v52, v32, v33
v_lshlrev_b32 v32, 16, v52
v_and_b32 v33, v15, v52
v_cvt_pk_bf16_f32 v52, v34, v35
v_lshlrev_b32 v34, 16, v52
v_and_b32 v35, v15, v52
v_cvt_pk_bf16_f32 v52, v36, v37
v_lshlrev_b32 v36, 16, v52
v_and_b32 v37, v15, v52
v_cvt_pk_bf16_f32 v52, v38, v39
v_lshlrev_b32 v38, 16, v52
v_and_b32 v39, v15, v52
v_cvt_pk_bf16_f32 v52, v40, v41
v_lshlrev_b32 v40, 16, v52
v_and_b32 v41, v15, v52
v_cvt_pk_bf16_f32 v52, v42, v43
v_lshlrev_b32 v42, 16, v52
v_and_b32 v43, v15, v52
v_cvt_pk_bf16_f32 v52, v44, v45
v_lshlrev_b32 v44, 16, v52
v_and_b32 v45, v15, v52
v_cvt_pk_bf16_f32 v52, v46, v47
v_lshlrev_b32 v46, 16, v52
v_and_b32 v47, v15, v52
v_pk_add_f32 v[48:49], v[32:33], v[34:35]
v_pk_add_f32 v[50:51], v[36:37], v[38:39]
v_pk_add_f32 v[52:53], v[40:41], v[42:43]
v_pk_add_f32 v[54:55], v[44:45], v[46:47]
v_pk_add_f32 v[48:49], v[48:49], v[50:51]
v_pk_add_f32 v[52:53], v[52:53], v[54:55]
v_pk_add_f32 v[48:49], v[48:49], v[52:53]
v_add_f32 v48, v48, v49
s_nop 1
v_add_f32_dpp v48, v48, v48 quad_perm:[1,0,3,2] row_mask:0xf bank_mask:0xf
s_nop 1
v_add_f32_dpp v48, v48, v48 quad_perm:[2,3,0,1] row_mask:0xf bank_mask:0xf
s_nop 1
v_add_f32_dpp v48, v48, v48 row_half_mirror row_mask:0xf bank_mask:0xf
s_nop 1
v_add_f32_dpp v48, v48, v48 row_mirror row_mask:0xf bank_mask:0xf
s_nop 1
v_add_f32_dpp v48, v48, v48 row_bcast:15 row_mask:0xa bank_mask:0xf
s_nop 1
v_add_f32_dpp v48, v48, v48 row_bcast:31 row_mask:0xc bank_mask:0xf
s_nop 0
v_readlane_b32 s14, v48, 63
v_mov_b32 v60, 0x3a800000
s_nop 0
v_mul_f32 v48, s14, v60
v_pk_add_f32 v[52:53], v[32:33], v[48:49] op_sel_hi:[1,0] neg_lo:[0,1] neg_hi:[0,1]
v_pk_add_f32 v[54:55], v[34:35], v[48:49] op_sel_hi:[1,0] neg_lo:[0,1] neg_hi:[0,1]
v_pk_mul_f32 v[50:51], v[52:53], v[52:53]
v_pk_mul_f32 v[62:63], v[54:55], v[54:55]
v_pk_add_f32 v[52:53], v[36:37], v[48:49] op_sel_hi:[1,0] neg_lo:[0,1] neg_hi:[0,1]
v_pk_add_f32 v[54:55], v[38:39], v[48:49] op_sel_hi:[1,0] neg_lo:[0,1] neg_hi:[0,1]
v_pk_fma_f32 v[50:51], v[52:53], v[52:53], v[50:51]
v_pk_fma_f32 v[62:63], v[54:55], v[54:55], v[62:63]
v_pk_add_f32 v[52:53], v[40:41], v[48:49] op_sel_hi:[1,0] neg_lo:[0,1] neg_hi:[0,1]
v_pk_add_f32 v[54:55], v[42:43], v[48:49] op_sel_hi:[1,0] neg_lo:[0,1] neg_hi:[0,1]
v_pk_fma_f32 v[50:51], v[52:53], v[52:53], v[50:51]
v_pk_fma_f32 v[62:63], v[54:55], v[54:55], v[62:63]
v_pk_add_f32 v[52:53], v[44:45], v[48:49] op_sel_hi:[1,0] neg_lo:[0,1] neg_hi:[0,1]
v_pk_add_f32 v[54:55], v[46:47], v[48:49] op_sel_hi:[1,0] neg_lo:[0,1] neg_hi:[0,1]
v_pk_fma_f32 v[50:51], v[52:53], v[52:53], v[50:51]
v_pk_fma_f32 v[62:63], v[54:55], v[54:55], v[62:63]
v_pk_add_f32 v[50:51], v[50:51], v[62:63]
v_add_f32 v49, v50, v51
s_nop 1
v_add_f32_dpp v49, v49, v49 quad_perm:[1,0,3,2] row_mask:0xf bank_mask:0xf
s_nop 1
v_add_f32_dpp v49, v49, v49 quad_perm:[2,3,0,1] row_mask:0xf bank_mask:0xf
s_nop 1
v_add_f32_dpp v49, v49, v49 row_half_mirror row_mask:0xf bank_mask:0xf
s_nop 1
v_add_f32_dpp v49, v49, v49 row_mirror row_mask:0xf bank_mask:0xf
s_nop 1
v_add_f32_dpp v49, v49, v49 row_bcast:15 row_mask:0xa bank_mask:0xf
s_nop 1
v_add_f32_dpp v49, v49, v49 row_bcast:31 row_mask:0xc bank_mask:0xf
s_nop 0
v_readlane_b32 s14, v49, 63
s_nop 1
v_mul_f32 v49, s14, v60
v_cvt_pk_bf16_f32 v48, v48, v49
v_and_b32 v49, v15, v48
v_lshlrev_b32 v48, 16, v48
v_add_f32 v49, 0x3727c5ac, v49
v_cvt_pk_bf16_f32 v49, v49, v49
v_and_b32 v49, v15, v49
v_sqrt_f32 v49, v49
s_nop 0
v_cvt_pk_bf16_f32 v49, v49, v49
v_and_b32 v49, v15, v49
v_rcp_f32 v50, v49
v_pk_add_f32 v[56:57], v[56:57], v[48:49] op_sel_hi:[1,0] neg_lo:[0,1] neg_hi:[0,1]
v_pk_add_f32 v[58:59], v[58:59], v[48:49] op_sel_hi:[1,0] neg_lo:[0,1] neg_hi:[0,1]
v_cvt_pk_bf16_f32 v52, v56, v57
v_lshlrev_b32 v56, 16, v52
v_and_b32 v57, v15, v52
v_pk_mul_f32 v[52:53], v[56:57], v[50:51] op_sel_hi:[1,0]
v_pk_fma_f32 v[56:57], v[52:53], v[48:49], v[56:57] op_sel:[0,1,0] op_sel_hi:[1,1,1] neg_lo:[1,0,0] neg_hi:[1,0,0]
v_pk_fma_f32 v[56:57], v[56:57], v[50:51], v[52:53] op_sel_hi:[1,0,1]
v_cvt_pk_bf16_f32 v52, v58, v59
v_lshlrev_b32 v58, 16, v52
v_and_b32 v59, v15, v52
v_pk_mul_f32 v[52:53], v[58:59], v[50:51] op_sel_hi:[1,0]
v_pk_fma_f32 v[58:59], v[52:53], v[48:49], v[58:59] op_sel:[0,1,0] op_sel_hi:[1,1,1] neg_lo:[1,0,0] neg_hi:[1,0,0]
v_pk_fma_f32 v[58:59], v[58:59], v[50:51], v[52:53] op_sel_hi:[1,0,1]
v_cvt_pk_bf16_f32 v60, v56, v56
v_cvt_pk_bf16_f32 v61, v57, v57
v_cvt_pk_bf16_f32 v62, v58, v58
v_cvt_pk_bf16_f32 v63, v59, v59
ds_write_b128 v16, v[60:63] offset:2048
s_mov_b64 exec, 1
ds_add_u32 v2, v3 offset:16132
s_mov_b64 exec, -1
s_branch L_lndone
L_oretry:
v_xor_b32 v16, v16, v6
v_xor_b32 v17, v17, v7
v_xor_b32 v18, v18, v8
v_xor_b32 v19, v19, v9
v_xor_b32 v20, v20, v6
v_xor_b32 v21, v21, v7
v_xor_b32 v22, v22, v8
v_xor_b32 v23, v23, v9
v_xor_b32 v24, v24, v6
v_xor_b32 v25, v25, v7
v_xor_b32 v26, v26, v8
v_xor_b32 v27, v27, v9
v_xor_b32 v28, v28, v6
v_xor_b32 v29, v29, v7
v_xor_b32 v30, v30, v8
v_xor_b32 v31, v31, v9
s_add_u32 s10, s10, 1
s_cmp_lt_u32 s10, 1048576
s_cbranch_scc1 GO_29
s_mov_b32 s15, 14
s_branch L_fail
L_oaddr:
s_and_b32 s14, s4, 3
s_lshl_b32 s14, s14, 2
s_add_u32 s14, s14, s3
s_lshl_b32 s14, s14, 8
s_lshr_b32 s15, s4, 2
s_lshl_b32 s15, s15, 5
s_add_u32 s15, s15, s5
s_lshr_b32 s15, s15, 4
s_lshl_b32 s15, s15, 6
s_add_u32 s14, s14, s15
s_add_u32 s14, s14, 16384
s_add_u32 s60, s56, s14
s_addc_u32 s61, s57, 0
s_and_b32 s14, s4, 3
s_lshl_b32 s14, s14, 1
s_lshr_b32 s15, s4, 2
s_add_u32 s14, s14, s15
s_lshl_b32 s14, s14, 14
s_lshl_b32 s15, s3, 12
s_add_u32 s14, s14, s15
s_add_u32 s62, s14, 163840
s_lshr_b32 s14, s3, 1
s_and_b32 s15, s6, 1
s_lshl_b32 s15, s15, 1
s_and_b32 s16, s3, 1
s_add_u32 s15, s15, s16
s_lshl_b32 s16, s14, 2
s_lshr_b32 s17, s6, 4
s_add_u32 s16, s16, s17
s_lshl_b32 s16, s16, 2
s_add_u32 s16, s16, s15
s_lshl_b32 s16, s16, 2
s_bfe_u32 s17, s6, 0x30001
s_lshl_b32 s17, s17, 2
s_add_u32 s17, s17, s7
s_lshr_b32 s17, s17, 3
s_add_u32 s16, s16, s17
s_lshl_b32 s16, s16, 7
s_add_u32 s16, s16, 32768
s_add_u32 s36, s56, s16
s_addc_u32 s37, s57, 0
s_lshl_b32 s16, s14, 5
s_lshr_b32 s17, s6, 1
s_add_u32 s16, s16, s17
s_lshl_b32 s16, s16, 2
s_add_u32 s16, s16, s15
s_lshl_b32 s38, s16, 12
s_add_u32 s38, s38, 1048576
s_lshl_b32 s39, s16, 8
s_add_u32 s39, s39, 98304
s_setpc_b64 s[94:95]
L_H:
s_call_b64 s[94:95], T_y
s_mov_b64 s[36:37], s[86:87]
s_load_dwordx2 s[40:41], s[0:1], 72
s_load_dwordx2 s[44:45], s[0:1], 80
s_mov_b32 s38, 7168
s_mov_b32 s39, 0x20000
s_mov_b32 s42, 2048
s_mov_b32 s43, 0x20000
s_mov_b32 s46, 4096
s_mov_b32 s47, 0x20000
v_and_b32 v16, 1, v1
v_lshrrev_b32 v17, 4, v1
v_lshl_add_u32 v16, v16, 2, v17
v_lshlrev_b32 v14, 1, v16
s_lshl_b32 s34, s4, 5
s_add_u32 s34, s34, s5
s_lshl_b32 s33, s34, 4
s_and_b32 s15, s33, 2047
v_and_b32 v16, 15, v1
v_lshlrev_b32 v16, 3, v16
s_lshl_b32 s17, s8, 7
s_waitcnt lgkmcnt(0)
buffer_load_ushort v10, v14, s[24:27], s33 offen
buffer_load_ushort v11, v14, s[40:43], s15 offen
buffer_load_dwordx2 v[12:13], v16, s[36:39], s17 offen
s_mul_i32 s12, s11, 0x9E3779B1
s_add_u32 s12, s12, 0x85EBCA77
s_mov_b32 s13, s12
s_mov_b32 s20, 0x07060500
s_mov_b32 s21, 0x07060501
s_mov_b32 s22, 0x07060502
s_mov_b32 s23, 0x07060503
v_mov_b32 v5, s12
v_and_b32 v6, 0xff, v5
v_bfe_u32 v7, v5, 8, 8
v_bfe_u32 v8, v5, 16, 8
v_lshrrev_b32 v9, 24, v5
v_lshrrev_b32 v80, 4, v1
v_and_b32 v81, 15, v1
v_lshlrev_b32 v81, 4, v81
v_lshl_add_u32 v80, v80, 14, v81
v_lshlrev_b32 v81, 6, v1
s_lshr_b32 s14, s6, 4
s_lshl_b32 s14, s14, 15
s_bfe_u32 s15, s6, 0x20002
s_lshl_b32 s15, s15, 12
s_add_u32 s14, s14, s15
s_lshl_b32 s15, s7, 10
s_add_u32 s14, s14, s15
s_and_b32 s15, s6, 3
s_lshl_b32 s15, s15, 8
s_add_u32 s14, s14, s15
s_add_u32 s30, s14, 163840
s_lshr_b32 s15, s6, 2
s_lshl_b32 s15, s15, 8
s_and_b32 s17, s6, 3
s_lshl_b32 s17, s17, 2
s_add_u32 s17, s17, s7
s_lshr_b32 s16, s17, 4
s_lshl_b32 s16, s16, 6
s_add_u32 s15, s15, s16
s_and_b32 s17, s17, 15
s_lshl_b32 s17, s17, 2
s_add_u32 s15, s15, s17
s_add_u32 s31, s15, 16384
PL_30:
ds_read_b32 v112, v2 offset:16136
ds_read_b128 v[96:99], v4 offset:4096
ds_read_b128 v[100:103], v4 offset:4608
ds_read_b128 v[104:107], v4 offset:5120
ds_read_b128 v[108:111], v4 offset:5632
s_waitcnt lgkmcnt(0)
v_readfirstlane_b32 s14, v112
s_cmp_ge_u32 s14, 4
s_cbranch_scc1 PD_31
s_add_u32 s10, s10, 1
s_cmp_lt_u32 s10, 1048576
s_cbranch_scc1 PL_30
s_mov_b32 s15, 5
s_branch L_fail
PD_31:
v_pk_add_f32 v[96:97], v[96:97], v[100:101]
v_pk_add_f32 v[98:99], v[98:99], v[102:103]
v_pk_add_f32 v[104:105], v[104:105], v[108:109]
v_pk_add_f32 v[106:107], v[106:107], v[110:111]
v_pk_add_f32 v[96:97], v[96:97], v[104:105]
v_pk_add_f32 v[98:99], v[98:99], v[106:107]
v_perm_b32 v96, v96, v5, s20
v_perm_b32 v97, v97, v5, s21
v_perm_b32 v98, v98, v5, s22
v_perm_b32 v99, v99, v5, s23
s_mov_b32 exec_hi, 0
buffer_store_dwordx4 v[96:99], v80, s[56:59], s30 offen sc1
s_mov_b32 exec_lo, 0xf
buffer_atomic_swap v5, v81, s[56:59], s31 offen sc1
s_mov_b64 exec, -1
s_call_b64 s[94:95], T_12
s_call_b64 s[94:95], T_16
s_call_b64 s[94:95], T_18
v_bfe_u32 v48, v1, 2, 3
v_lshlrev_b32 v48, 6, v48
v_and_b32 v49, 3, v1
v_lshl_add_u32 v48, v49, 2, v48
s_nop 0
s_lshl_b32 s52, s34, 5
s_add_u32 s52, s52, 409600
s_add_u32 s53, s52, 262144
v_lshrrev_b32 v50, 1, v1
v_mul_u32_u24 v50, 8192, v50
v_and_b32 v51, 1, v1
v_lshl_add_u32 v50, v51, 4, v50
s_waitcnt vmcnt(2)
v_lshlrev_b32 v10, 16, v10
v_lshlrev_b32 v11, 16, v11
v_add_f32 v10, v10, v11
v_mov_b32 v44, 0
v_mov_b32 v45, 0
v_mov_b32 v46, 0
v_mov_b32 v47, 0
s_cmp_eq_u32 s9, 0
s_cbranch_scc1 L_hwrite
s_lshl_b32 s62, s8, 11
s_add_u32 s62, s62, 294912
s_lshl_b32 s15, s7, 9
s_add_u32 s30, s62, s15
v_lshlrev_b32 v76, 16, v12
v_and_b32 v77, v15, v12
v_lshlrev_b32 v78, 16, v13
v_and_b32 v79, v15, v13
s_lshl_b32 s14, s8, 7
s_add_u32 s14, s14, 4096
s_add_u32 s60, s56, s14
s_addc_u32 s61, s57, 0
s_lshl_b32 s17, s7, 2
s_add_u32 s31, s14, s17
PL_32:
ds_read_b32 v112, v2 offset:16148
ds_read_b128 v[96:99], v4 offset:6144
ds_read_b128 v[100:103], v4 offset:6656
ds_read_b128 v[104:107], v4 offset:7168
ds_read_b128 v[108:111], v4 offset:7680
s_waitcnt lgkmcnt(0)
v_readfirstlane_b32 s14, v112
s_cmp_ge_u32 s14, 4
s_cbranch_scc1 PD_33
s_add_u32 s10, s10, 1
s_cmp_lt_u32 s10, 1048576
s_cbranch_scc1 PL_32
s_mov_b32 s15, 12
s_branch L_fail
T_12:
s_setpc_b64 s[94:95]
PD_33:
v_pk_add_f32 v[96:97], v[96:97], v[100:101]
v_pk_add_f32 v[98:99], v[98:99], v[102:103]
v_pk_add_f32 v[104:105], v[104:105], v[108:109]
v_pk_add_f32 v[106:107], v[106:107], v[110:111]
v_pk_add_f32 v[96:97], v[96:97], v[104:105]
v_pk_add_f32 v[98:99], v[98:99], v[106:107]
v_perm_b32 v96, v96, v5, s20
v_perm_b32 v97, v97, v5, s21
v_perm_b32 v98, v98, v5, s22
v_perm_b32 v99, v99, v5, s23
s_mov_b32 exec_hi, 0
buffer_store_dwordx4 v[96:99], v4, s[56:59], s30 offen sc1
s_mov_b32 exec_lo, 1
buffer_atomic_swap v5, v2, s[56:59], s31 offen sc1
s_mov_b64 exec, -1
HL_34:
s_load_dwordx4 s[64:67], s[60:61], 0 glc
s_waitcnt lgkmcnt(0)
s_cmp_eq_u64 s[64:65], s[12:13]
s_cbranch_scc0 HR_36
s_cmp_eq_u64 s[66:67], s[12:13]
s_cbranch_scc0 HR_36
s_branch HD_35
HR_36:
s_add_u32 s10, s10, 1
s_cmp_lt_u32 s10, 1048576
s_cbranch_scc1 HL_34
s_mov_b32 s15, 15
s_branch L_fail
HD_35:
GH_37:
buffer_load_dwordx4 v[16:19], v4, s[56:59], s62 offen offset:0 sc1
buffer_load_dwordx4 v[20:23], v4, s[56:59], s62 offen offset:1024 sc1
s_waitcnt vmcnt(0)
v_xor_b32 v16, v16, v6
v_xor_b32 v17, v17, v7
v_xor_b32 v18, v18, v8
v_xor_b32 v19, v19, v9
v_xor_b32 v20, v20, v6
v_xor_b32 v21, v21, v7
v_xor_b32 v22, v22, v8
v_xor_b32 v23, v23, v9
v_or3_b32 v42, v16, v17, v18
v_or3_b32 v42, v42, v19, v20
v_or3_b32 v42, v42, v21, v22
v_or_b32 v42, v42, v23
v_lshlrev_b32 v42, 24, v42
v_cmp_ne_u32 vcc, 0, v42
s_cbranch_vccz RD_38
s_add_u32 s10, s10, 1
s_cmp_lt_u32 s10, 1048576
s_cbranch_scc1 GH_37
s_mov_b32 s15, 16
s_branch L_fail
T_16:
s_setpc_b64 s[94:95]
RD_38:
L_hok:
v_pk_add_f32 v[16:17], v[16:17], v[20:21]
v_pk_add_f32 v[18:19], v[18:19], v[22:23]
v_mov_b32 v20, v16
v_mov_b32 v21, v17
v_mov_b32 v22, v18
v_mov_b32 v23, v19
v_permlane32_swap_b32 v16, v20
v_permlane32_swap_b32 v17, v21
v_permlane32_swap_b32 v18, v22
v_permlane32_swap_b32 v19, v23
v_pk_add_f32 v[16:17], v[16:17], v[20:21]
v_pk_add_f32 v[18:19], v[18:19], v[22:23]
v_cvt_pk_bf16_f32 v52, v16, v17
v_lshlrev_b32 v16, 16, v52
v_and_b32 v17, v15, v52
v_cvt_pk_bf16_f32 v52, v18, v19
v_lshlrev_b32 v18, 16, v52
v_and_b32 v19, v15, v52
v_pk_add_f32 v[16:17], v[16:17], v[76:77]
v_pk_add_f32 v[18:19], v[18:19], v[78:79]
v_cvt_pk_bf16_f32 v52, v16, v17
v_lshlrev_b32 v16, 16, v52
v_and_b32 v17, v15, v52
v_cvt_pk_bf16_f32 v52, v18, v19
v_lshlrev_b32 v18, 16, v52
v_and_b32 v19, v15, v52
s_mov_b32 s14, 0x3d372713
s_mov_b32 s15, 0xc0135761
v_pk_mul_f32 v[24:25], v[16:17], v[16:17]
v_pk_mul_f32 v[26:27], v[18:19], v[18:19]
v_pk_mul_f32 v[24:25], v[24:25], v[16:17]
v_pk_mul_f32 v[26:27], v[26:27], v[18:19]
v_fma_f32 v24, s14, v24, v16
v_fma_f32 v25, s14, v25, v17
v_fma_f32 v26, s14, v26, v18
v_fma_f32 v27, s14, v27, v19
v_mul_f32 v24, s15, v24
v_mul_f32 v25, s15, v25
v_mul_f32 v26, s15, v26
v_mul_f32 v27, s15, v27
v_exp_f32 v24, v24
v_exp_f32 v25, v25
v_exp_f32 v26, v26
v_exp_f32 v27, v27
v_add_f32 v24, 1.0, v24
v_add_f32 v25, 1.0, v25
v_add_f32 v26, 1.0, v26
v_add_f32 v27, 1.0, v27
v_rcp_f32 v24, v24
v_rcp_f32 v25, v25
v_rcp_f32 v26, v26
v_rcp_f32 v27, v27
v_pk_mul_f32 v[24:25], v[24:25], v[16:17]
v_pk_mul_f32 v[26:27], v[26:27], v[18:19]
v_cvt_pk_bf16_f32 v44, v24, v24
v_cvt_pk_bf16_f32 v45, v25, v25
v_cvt_pk_bf16_f32 v46, v26, v26
v_cvt_pk_bf16_f32 v47, v27, v27
L_hwrite:
ds_write_b32 v48, v44 offset:15616
ds_write_b32 v48, v45 offset:15632
ds_write_b32 v48, v46 offset:15648
ds_write_b32 v48, v47 offset:15664
s_mov_b64 exec, 1
ds_add_u32 v2, v3 offset:16164
s_mov_b64 exec, -1
s_waitcnt lgkmcnt(0)
s_barrier
PL_39:
ds_read_b32 v32, v2 offset:16176
s_waitcnt lgkmcnt(0)
v_readfirstlane_b32 s14, v32
s_cmp_ge_u32 s14, 4
s_cbranch_scc1 PD_40
s_add_u32 s10, s10, 1
s_cmp_lt_u32 s10, 1048576
s_cbranch_scc1 PL_39
s_mov_b32 s15, 18
s_branch L_fail
T_18:
s_setpc_b64 s[94:95]
PD_40:
GF_41:
buffer_load_dwordx4 v[64:67], v50, s[56:59], s52 offen sc1
buffer_load_dwordx4 v[68:71], v50, s[56:59], s53 offen sc1
s_waitcnt vmcnt(0)
v_xor_b32 v64, v64, v6
v_xor_b32 v65, v65, v7
v_xor_b32 v66, v66, v8
v_xor_b32 v67, v67, v9
v_xor_b32 v68, v68, v6
v_xor_b32 v69, v69, v7
v_xor_b32 v70, v70, v8
v_xor_b32 v71, v71, v9
v_or3_b32 v42, v64, v65, v66
v_or3_b32 v42, v42, v67, v68
v_or3_b32 v42, v42, v69, v70
v_or_b32 v42, v42, v71
v_lshlrev_b32 v42, 24, v42
v_pk_add_f32 v[44:45], v[64:65], v[68:69]
v_pk_add_f32 v[46:47], v[66:67], v[70:71]
v_cmp_ne_u32 vcc, 0, v42
s_cbranch_vccz GD_42
s_add_u32 s10, s10, 1
s_cmp_lt_u32 s10, 1048576
s_cbranch_scc1 GF_41
s_mov_b32 s15, 17
s_branch L_fail
GD_42:
v_permlane32_swap_b32 v44, v46
v_permlane32_swap_b32 v45, v47
v_add_f32 v44, v44, v46
v_add_f32 v45, v45, v47
s_nop 1
v_permlane16_swap_b32 v44, v45
v_add_f32 v44, v44, v45
s_nop 1
v_add_f32_dpp v44, v44, v44 quad_perm:[2,3,0,1] row_mask:0xf bank_mask:0xf
s_nop 1
v_add_f32_dpp v44, v44, v44 row_ror:4 row_mask:0xf bank_mask:0xf
s_nop 1
v_add_f32_dpp v44, v44, v44 row_ror:8 row_mask:0xf bank_mask:0xf
s_mov_b32 exec_lo, 0x00030003
s_mov_b32 exec_hi, 0x00030003
v_add_f32 v44, v44, v10
v_cvt_pk_bf16_f32 v44, v44, v44
buffer_store_short v44, v14, s[44:47], s33 offen
s_cmp_lg_u32 s2, 0
s_cbranch_scc1 L_noep
s_add_u32 s11, s11, 1
v_mov_b32 v45, s11
s_mov_b64 exec, 1
buffer_store_dword v45, v2, s[56:59], 0 offen
L_noep:
s_mov_b64 exec, -1
L_exit:
L_end:
s_endpgm
L_fail:
s_load_dwordx2 s[48:49], s[0:1], 88
s_mov_b32 s50, 256
s_mov_b32 s51, 0x20000
s_lshl_b32 s14, s15, 2
v_mov_b32 v20, s2
v_add_u32 v20, 1, v20
s_waitcnt lgkmcnt(0)
s_mov_b64 exec, 1
buffer_store_dword v20, v2, s[48:51], s14 offen
s_endpgm
.section .rodata,"a"
.p2align 6
.amdhsa_kernel parallel_sum__sliding_block_cached__mixer_channel_mlp__decode_kernel
  .amdhsa_next_free_vgpr 168
  .amdhsa_next_free_sgpr 102
  .amdhsa_accum_offset 168
  .amdhsa_group_segment_fixed_size 0
  .amdhsa_kernarg_size 104
  .amdhsa_user_sgpr_count 2
  .amdhsa_user_sgpr_kernarg_segment_ptr 1
  .amdhsa_system_sgpr_workgroup_id_x 1
  .amdhsa_float_denorm_mode_32 3
.end_amdhsa_kernel
```
